```python
import torch

def _softmax(x, axis=-1):
    return torch.softmax(x, dim=axis)
def _gelu(x):
    return torch.nn.functional.gelu(x, approximate="tanh")
def _silu(x):
    return torch.nn.functional.silu(x)
def _sigmoid(x):
    return torch.sigmoid(x)
def _layernorm(x, axis=-1, eps=1e-5):
    m = x.mean(dim=axis, keepdim=True)
    v = x.var(dim=axis, keepdim=True, unbiased=False)
    return (x - m) / torch.sqrt(v + eps)
def _scatter_add(tgt, idx, src, axis=0):
    return tgt.clone().index_add_(axis, idx, src)
def _segment_sum(src, seg, n):
    out = torch.zeros((n,) + src.shape[1:], dtype=src.dtype)
    return out.index_add_(0, seg, src)
def _pad(x, pw):
    flat = tuple(v for pair in reversed(pw) for v in pair)
    return torch.nn.functional.pad(x, flat)

kernel_name = 'standalone__modern_conv_block_convnext__vision'

def setup_inputs():

    _w = (lambda a: (lambda t: t.to(torch.bfloat16) if t.is_floating_point() else t)(torch.as_tensor(a)))
    H = W = 512
    C = 96
    K = 1
    return {
        "x": _w((lambda *s: torch.randn(*s, dtype=torch.bfloat16) * 0.05)(1, H, W, C)),
        "dw": _w((lambda *s: torch.randn(*s, dtype=torch.bfloat16) * 0.1)(K, K, C)),
        "w1": _w((lambda *s: torch.randn(*s, dtype=torch.bfloat16) * 0.1)(C, 4 * C)),
        "b1": _w((lambda *s: torch.randn(*s, dtype=torch.bfloat16) * 0.4)(4 * C)),
        "w2": _w((lambda *s: torch.randn(*s, dtype=torch.bfloat16) * 0.05)(4 * C, C)),
        "b2": _w((lambda *s: torch.randn(*s, dtype=torch.bfloat16) * 0.4)(C)),
        "gamma": _w((lambda *s: torch.randn(*s, dtype=torch.bfloat16) * 0.05)(C)),
    }

def reference(x, dw, w1, b1, w2, b2, gamma):
    B, H, W, C = x.shape
    K = dw.shape[0]
    pad = K // 2
    xp = _pad(x, ((0,0),(pad,pad),(pad,pad),(0,0)))
    out = torch.zeros_like(x)
    for i in range(K):
        for j in range(K):
            out = out + xp[:, i:i+H, j:j+W, :] * dw[i, j][None, None, None, :]
    h = _layernorm(out, axis=-1)
    h = torch.einsum('bhwc,ce->bhwe', h, w1) + b1
    h = _gelu(h)
    h = torch.einsum('bhwe,ec->bhwc', h, w2) + b2
    return x + gamma[None, None, None, :] * h
```

```asm
; @launch grid=(256,1,1) block=(512,1,1) lds=149888
.amdgcn_target "amdgcn-amd-amdhsa--gfx950"
.text
.globl standalone__modern_conv_block_convnext__vision_kernel
.p2align 8
.type standalone__modern_conv_block_convnext__vision_kernel,@function
standalone__modern_conv_block_convnext__vision_kernel:
  s_cmp_ge_u32 s2, 256
  s_cbranch_scc1 L_end
  s_load_dwordx16 s[4:19], s[0:1], 0
  v_and_b32 v104, 63, v0
  v_lshrrev_b32 v115, 6, v0
  v_and_b32 v105, 31, v104
  v_readfirstlane_b32 s36, v115
  v_lshrrev_b32 v106, 5, v104
  v_mul_u32_u24 v239, 192, v105
  v_lshl_add_u32 v239, v106, 4, v239
  v_lshlrev_b32 v236, 4, v104
  v_add_u32 v237, 0x10000, v236
  v_add_u32 v238, 0x20000, v236
  v_and_b32 v107, 19, v105
  v_and_b32 v115, 4, v105
  v_lshl_add_u32 v107, v115, 1, v107
  v_and_b32 v115, 8, v105
  v_lshrrev_b32 v115, 1, v115
  v_add_u32 v107, v107, v115
  v_lshlrev_b32 v240, 4, v106
  v_lshlrev_b32 v241, 6, v106
  v_add_u32 v240, 147456, v240
  v_add_u32 v241, 147712, v241
  v_sub_u32 v242, 0, v106
  v_lshlrev_b32 v242, 16, v242
  v_and_b32 v115, 15, v105
  v_mul_u32_u24 v251, 192, v115
  v_and_b32 v115, 16, v105
  v_lshl_add_u32 v251, v115, 1, v251
  v_lshl_add_u32 v251, v106, 4, v251
  s_mov_b32 s40, 0x44e944e9
  s_mov_b32 s41, 0x37803780
  s_mov_b32 s42, 0x3d422e45
  s_mov_b32 s43, 0xbc2aaaab
  s_mov_b32 s44, 0x3f800000
  s_mov_b32 s39, 0
  s_lshl_b32 s37, s2, 3
  s_add_u32 s37, s37, s36
  s_mul_i32 s37, s37, 6144
  s_add_u32 s38, s37, 12582912
  s_and_b32 s45, s36, 3
  v_add_u32 v250, s37, v239
  v_min_u32 v117, 47, v104
  v_lshlrev_b32 v118, 4, v117
  v_lshlrev_b32 v117, 2, v117
  v_mov_b32 v114, 0
  s_waitcnt lgkmcnt(0)
  s_mov_b32 s20, s4
  s_mov_b32 s21, s5
  s_mov_b32 s22, 50331648
  s_mov_b32 s23, 0x00020000
  s_mov_b32 s28, s8
  s_mov_b32 s29, s9
  s_mov_b32 s30, 73728
  s_mov_b32 s31, 0x00020000
  s_mov_b32 s32, s12
  s_mov_b32 s33, s13
  s_mov_b32 s34, 73728
  s_mov_b32 s35, 0x00020000
  s_lshr_b32 s46, s2, 3
  s_and_b32 s46, s46, 31
  s_lshl_b32 s46, s46, 2
  s_add_u32 s46, s46, s45
  s_mul_i32 s46, s46, 576
  v_min_u32 v131, 8, v104
  v_lshlrev_b32 v131, 6, v131
  s_cmp_ge_u32 s36, 4
  s_cbranch_scc1 L_pfB
  buffer_load_dword v131, v131, s[28:31], s46 offen
  s_branch L_pfD
L_pfB:
  buffer_load_dword v131, v131, s[32:35], s46 offen
L_pfD:
  v_and_b32 v115, 27, v105
  v_cmp_eq_u32 vcc, 0, v115
  v_lshlrev_b32 v115, 2, v104
  v_add_u32 v115, 149632, v115
  ds_write_b32 v115, v114
  v_add_u32 v116, 2176, v240
  v_cndmask_b32 v240, v116, v240, vcc
  s_mov_b32 m0, 147456
  s_nop 0
  global_load_lds_dword v117, s[6:7]
  s_mov_b32 m0, 148096
  s_nop 0
  global_load_lds_dword v117, s[16:17]
  s_mov_b32 m0, 148352
  s_nop 0
  global_load_lds_dword v117, s[14:15]
  s_mov_b32 m0, 148608
  s_nop 0
  global_load_lds_dwordx4 v118, s[10:11]
  s_mov_b32 s24, s18
  s_mov_b32 s25, s19
  s_mov_b32 s26, 50331648
  s_mov_b32 s27, 0x00020000
  v_lshrrev_b32 v117, 2, v104
  v_mul_u32_u24 v117, 768, v117
  v_and_b32 v118, 3, v104
  v_lshl_add_u32 v119, v118, 4, v117
  s_cmp_ge_u32 s36, 4
  s_cbranch_scc1 L_grpB
  s_add_u32 s48, s45, 0
  s_and_b32 s45, s36, 3
  s_mul_i32 s45, s45, 6144
  s_add_u32 s45, s45, 122880
  v_add_u32 v116, s37, v236
  s_add_u32 s46, s45, 0
  s_mov_b32 m0, s46
  s_movk_i32 s47, 0
  s_nop 0
  buffer_load_dwordx4 v116, s[20:23], s47 offen lds
  s_add_u32 s46, s45, 1024
  s_mov_b32 m0, s46
  s_movk_i32 s47, 1024
  s_nop 0
  buffer_load_dwordx4 v116, s[20:23], s47 offen lds
  s_add_u32 s46, s45, 2048
  s_mov_b32 m0, s46
  s_movk_i32 s47, 2048
  s_nop 0
  buffer_load_dwordx4 v116, s[20:23], s47 offen lds
  s_add_u32 s46, s45, 3072
  s_mov_b32 m0, s46
  s_movk_i32 s47, 3072
  s_nop 0
  buffer_load_dwordx4 v116, s[20:23], s47 offen lds
  s_add_u32 s46, s45, 4096
  s_mov_b32 m0, s46
  s_movk_i32 s47, 4096
  s_nop 0
  buffer_load_dwordx4 v116, s[20:23], s47 offen lds
  s_add_u32 s46, s45, 5120
  s_mov_b32 m0, s46
  s_movk_i32 s47, 5120
  s_nop 0
  buffer_load_dwordx4 v116, s[20:23], s47 offen lds
  s_mul_i32 s45, s48, 6144
  s_add_u32 s46, s45, 0
  s_mov_b32 m0, s46
  s_lshl_b32 s47, s48, 6
  s_add_u32 s47, s47, 0
  buffer_load_dwordx4 v119, s[28:31], s47 offen lds
  s_add_u32 s46, s45, 1024
  s_mov_b32 m0, s46
  s_lshl_b32 s47, s48, 6
  s_add_u32 s47, s47, 12288
  buffer_load_dwordx4 v119, s[28:31], s47 offen lds
  s_add_u32 s46, s45, 2048
  s_mov_b32 m0, s46
  s_lshl_b32 s47, s48, 6
  s_add_u32 s47, s47, 24576
  buffer_load_dwordx4 v119, s[28:31], s47 offen lds
  s_add_u32 s46, s45, 3072
  s_mov_b32 m0, s46
  s_lshl_b32 s47, s48, 6
  s_add_u32 s47, s47, 36864
  buffer_load_dwordx4 v119, s[28:31], s47 offen lds
  s_add_u32 s46, s45, 4096
  s_mov_b32 m0, s46
  s_lshl_b32 s47, s48, 6
  s_add_u32 s47, s47, 49152
  buffer_load_dwordx4 v119, s[28:31], s47 offen lds
  s_add_u32 s46, s45, 5120
  s_mov_b32 m0, s46
  s_lshl_b32 s47, s48, 6
  s_add_u32 s47, s47, 61440
  buffer_load_dwordx4 v119, s[28:31], s47 offen lds
  s_waitcnt vmcnt(12)
  v_lshlrev_b32 v115, 1, v107
  v_add_u32 v115, 147456, v115
  v_mov_b32 v114, 147456
  ds_read_u16 v64, v115 offset:0
  ds_read_u16 v65, v115 offset:64
  ds_read_u16 v66, v115 offset:128
  ds_read_u16 v235, v114 offset:190
  s_lshl_b32 s46, s48, 6
  v_add_u32 v116, s46, v115
  ds_read_u16 v110, v116 offset:1152
  v_lshrrev_b32 v115, 2, v105
  v_and_b32 v115, 1, v115
  v_and_b32 v116, 7, v107
  v_and_b32 v117, 1, v116
  v_lshlrev_b32 v117, 4, v117
  v_mov_b32 v118, 0xffff
  v_lshlrev_b32 v70, v117, v118
  v_mov_b32 v71, 1
  v_lshrrev_b32 v116, 1, v116
  v_lshrrev_b32 v117, 4, v105
  v_lshl_add_u32 v116, v117, 2, v116
  v_xor_b32 v115, v115, v106
  v_lshl_add_u32 v116, v115, 3, v116
  v_lshlrev_b32 v116, v116, v71
  v_bfe_i32 v56, v116, 0, 1
  v_bfe_i32 v57, v116, 1, 1
  v_bfe_i32 v58, v116, 2, 1
  v_bfe_i32 v59, v116, 3, 1
  v_bfe_i32 v60, v116, 4, 1
  v_bfe_i32 v61, v116, 5, 1
  v_bfe_i32 v62, v116, 6, 1
  v_bfe_i32 v63, v116, 7, 1
  v_and_b32 v56, v56, v70
  v_and_b32 v57, v57, v70
  v_and_b32 v58, v58, v70
  v_and_b32 v59, v59, v70
  v_and_b32 v60, v60, v70
  v_and_b32 v61, v61, v70
  v_and_b32 v62, v62, v70
  v_and_b32 v63, v63, v70
  v_and_b32 v115, 1, v104
  v_lshlrev_b32 v115, 3, v115
  v_and_b32 v116, 2, v104
  v_lshl_add_u32 v115, v116, 1, v115
  v_and_b32 v116, 16, v104
  v_add_u32 v115, v115, v116
  v_lshlrev_b32 v115, 1, v115
  v_lshrrev_b32 v116, 2, v104
  v_and_b32 v116, 3, v116
  v_lshl_add_u32 v116, v106, 3, v116
  v_lshl_add_u32 v108, v116, 6, v115
  s_waitcnt lgkmcnt(0)
  v_lshl_or_b32 v115, v64, 16, v64
  v_and_b32 v200, v115, v56
  v_and_b32 v201, v115, v57
  v_and_b32 v202, v115, v58
  v_and_b32 v203, v115, v59
  v_and_b32 v204, v115, v60
  v_and_b32 v205, v115, v61
  v_and_b32 v206, v115, v62
  v_and_b32 v207, v115, v63
  v_lshl_or_b32 v115, v65, 16, v65
  v_and_b32 v208, v115, v56
  v_and_b32 v209, v115, v57
  v_and_b32 v210, v115, v58
  v_and_b32 v211, v115, v59
  v_and_b32 v212, v115, v60
  v_and_b32 v213, v115, v61
  v_and_b32 v214, v115, v62
  v_and_b32 v215, v115, v63
  v_lshl_or_b32 v115, v66, 16, v66
  v_and_b32 v216, v115, v56
  v_and_b32 v217, v115, v57
  v_and_b32 v218, v115, v58
  v_and_b32 v219, v115, v59
  v_and_b32 v220, v115, v60
  v_and_b32 v221, v115, v61
  v_and_b32 v222, v115, v62
  v_and_b32 v223, v115, v63
  v_mov_b32 v232, 0
  v_mov_b32 v233, 0
  v_mov_b32 v234, 0
  v_xor_b32 v235, 0x8000, v235
  v_lshlrev_b32 v235, 16, v235
  v_and_b32 v235, v235, v242
  v_and_b32 v224, 0x3f803f80, v56
  v_and_b32 v225, 0x3f803f80, v57
  v_and_b32 v226, 0x3f803f80, v58
  v_and_b32 v227, 0x3f803f80, v59
  v_and_b32 v228, 0x3f803f80, v60
  v_and_b32 v229, 0x3f803f80, v61
  v_and_b32 v230, 0x3f803f80, v62
  v_and_b32 v231, 0x3f803f80, v63
  s_and_b32 s45, s36, 3
  s_mul_i32 s45, s45, 6144
  s_add_u32 s45, s45, 122880
  v_add_u32 v116, s45, v239
  s_waitcnt vmcnt(6)
  ds_read_b128 v[160:163], v116 offset:0
  ds_read_b128 v[164:167], v116 offset:32
  ds_read_b128 v[168:171], v116 offset:64
  ds_read_b128 v[172:175], v116 offset:96
  ds_read_b128 v[176:179], v116 offset:128
  ds_read_b128 v[180:183], v116 offset:160
  s_waitcnt lgkmcnt(0)
  s_waitcnt lgkmcnt(0)
  ds_read_b128 v[136:139], v240 offset:0
  ds_read_b128 v[140:143], v240 offset:32
  ds_read_b128 v[144:147], v240 offset:64
  ds_read_b128 v[148:151], v240 offset:96
  v_mfma_f32_32x32x16_bf16 v[72:87], v[232:235], v[180:183], 0
  s_waitcnt lgkmcnt(3)
  v_mfma_f32_32x32x16_bf16 v[184:199], v[136:139], v[160:163], 0
  ds_read_b128 v[152:155], v240 offset:128
  s_waitcnt lgkmcnt(3)
  v_mfma_f32_32x32x16_bf16 v[184:199], v[140:143], v[164:167], v[184:199]
  ds_read_b128 v[156:159], v240 offset:160
  s_waitcnt lgkmcnt(3)
  v_mfma_f32_32x32x16_bf16 v[184:199], v[144:147], v[168:171], v[184:199]
  s_waitcnt lgkmcnt(2)
  v_mfma_f32_32x32x16_bf16 v[184:199], v[148:151], v[172:175], v[184:199]
  s_waitcnt lgkmcnt(1)
  v_mfma_f32_32x32x16_bf16 v[184:199], v[152:155], v[176:179], v[184:199]
  s_waitcnt lgkmcnt(0)
  v_mfma_f32_32x32x16_bf16 v[184:199], v[156:159], v[180:183], v[184:199]
  v_mfma_f32_32x32x16_bf16 v[88:103], v[200:203], v[160:163], v[72:87]
  v_mfma_f32_32x32x16_bf16 v[88:103], v[204:207], v[164:167], v[88:103]
  v_mfma_f32_32x32x16_bf16 v[120:135], v[208:211], v[168:171], v[72:87]
  v_mfma_f32_32x32x16_bf16 v[120:135], v[212:215], v[172:175], v[120:135]
  s_nop 7
  v_fmamk_f32 v243, v72, 0x42c00000, v184
  v_mfma_f32_32x32x16_bf16 v[184:199], v[216:219], v[176:179], v[72:87]
  v_mfma_f32_32x32x16_bf16 v[184:199], v[220:223], v[180:183], v[184:199]
  v_pk_mul_f32 v[244:245], v[88:89], v[88:89]
  v_pk_mul_f32 v[246:247], v[90:91], v[90:91]
  v_pk_fma_f32 v[244:245], v[92:93], v[92:93], v[244:245]
  v_pk_fma_f32 v[246:247], v[94:95], v[94:95], v[246:247]
  v_pk_fma_f32 v[244:245], v[96:97], v[96:97], v[244:245]
  v_pk_fma_f32 v[246:247], v[98:99], v[98:99], v[246:247]
  v_pk_fma_f32 v[244:245], v[100:101], v[100:101], v[244:245]
  v_pk_fma_f32 v[246:247], v[102:103], v[102:103], v[246:247]
  v_pk_fma_f32 v[244:245], v[120:121], v[120:121], v[244:245]
  v_pk_fma_f32 v[246:247], v[122:123], v[122:123], v[246:247]
  v_pk_fma_f32 v[244:245], v[124:125], v[124:125], v[244:245]
  v_pk_fma_f32 v[246:247], v[126:127], v[126:127], v[246:247]
  v_pk_fma_f32 v[244:245], v[128:129], v[128:129], v[244:245]
  v_pk_fma_f32 v[246:247], v[130:131], v[130:131], v[246:247]
  v_pk_fma_f32 v[244:245], v[132:133], v[132:133], v[244:245]
  v_pk_fma_f32 v[246:247], v[134:135], v[134:135], v[246:247]
  v_pk_fma_f32 v[244:245], v[184:185], v[184:185], v[244:245]
  v_pk_fma_f32 v[246:247], v[186:187], v[186:187], v[246:247]
  v_pk_fma_f32 v[244:245], v[188:189], v[188:189], v[244:245]
  v_pk_fma_f32 v[246:247], v[190:191], v[190:191], v[246:247]
  v_pk_fma_f32 v[244:245], v[192:193], v[192:193], v[244:245]
  v_pk_fma_f32 v[246:247], v[194:195], v[194:195], v[246:247]
  v_pk_fma_f32 v[244:245], v[196:197], v[196:197], v[244:245]
  v_pk_fma_f32 v[246:247], v[198:199], v[198:199], v[246:247]
  v_add_f32 v244, v244, v245
  v_add_f32 v246, v246, v247
  v_mul_f32 v249, v243, v243
  v_add_f32 v244, v244, v246
  v_mov_b32 v247, 0x383ee32f
  v_mov_b32 v245, v244
  s_nop 1
  v_permlane32_swap_b32 v244, v245
  v_add_f32 v244, v244, v245
  v_fma_f32 v244, v249, s43, v244
  v_fma_f32 v244, |v244|, s42, v247
  v_rsq_f32 v248, v244
  s_nop 0
  v_pk_mul_f32 v[88:89], v[88:89], v[248:249] op_sel_hi:[1,0]
  v_pk_mul_f32 v[90:91], v[90:91], v[248:249] op_sel_hi:[1,0]
  v_pk_mul_f32 v[92:93], v[92:93], v[248:249] op_sel_hi:[1,0]
  v_pk_mul_f32 v[94:95], v[94:95], v[248:249] op_sel_hi:[1,0]
  v_pk_mul_f32 v[96:97], v[96:97], v[248:249] op_sel_hi:[1,0]
  v_pk_mul_f32 v[98:99], v[98:99], v[248:249] op_sel_hi:[1,0]
  v_pk_mul_f32 v[100:101], v[100:101], v[248:249] op_sel_hi:[1,0]
  v_pk_mul_f32 v[102:103], v[102:103], v[248:249] op_sel_hi:[1,0]
  v_cvt_pk_bf16_f32 v48, v88, v89
  v_cvt_pk_bf16_f32 v49, v90, v91
  v_cvt_pk_bf16_f32 v50, v92, v93
  v_cvt_pk_bf16_f32 v51, v94, v95
  v_cvt_pk_bf16_f32 v52, v96, v97
  v_cvt_pk_bf16_f32 v53, v98, v99
  v_cvt_pk_bf16_f32 v54, v100, v101
  v_cvt_pk_bf16_f32 v55, v102, v103
  v_pk_mul_f32 v[120:121], v[120:121], v[248:249] op_sel_hi:[1,0]
  v_pk_mul_f32 v[122:123], v[122:123], v[248:249] op_sel_hi:[1,0]
  v_pk_mul_f32 v[124:125], v[124:125], v[248:249] op_sel_hi:[1,0]
  v_pk_mul_f32 v[126:127], v[126:127], v[248:249] op_sel_hi:[1,0]
  v_pk_mul_f32 v[128:129], v[128:129], v[248:249] op_sel_hi:[1,0]
  v_pk_mul_f32 v[130:131], v[130:131], v[248:249] op_sel_hi:[1,0]
  v_pk_mul_f32 v[132:133], v[132:133], v[248:249] op_sel_hi:[1,0]
  v_pk_mul_f32 v[134:135], v[134:135], v[248:249] op_sel_hi:[1,0]
  v_cvt_pk_bf16_f32 v56, v120, v121
  v_cvt_pk_bf16_f32 v57, v122, v123
  v_cvt_pk_bf16_f32 v58, v124, v125
  v_cvt_pk_bf16_f32 v59, v126, v127
  v_cvt_pk_bf16_f32 v60, v128, v129
  v_cvt_pk_bf16_f32 v61, v130, v131
  v_cvt_pk_bf16_f32 v62, v132, v133
  v_cvt_pk_bf16_f32 v63, v134, v135
  v_pk_mul_f32 v[184:185], v[184:185], v[248:249] op_sel_hi:[1,0]
  v_pk_mul_f32 v[186:187], v[186:187], v[248:249] op_sel_hi:[1,0]
  v_pk_mul_f32 v[188:189], v[188:189], v[248:249] op_sel_hi:[1,0]
  v_pk_mul_f32 v[190:191], v[190:191], v[248:249] op_sel_hi:[1,0]
  v_pk_mul_f32 v[192:193], v[192:193], v[248:249] op_sel_hi:[1,0]
  v_pk_mul_f32 v[194:195], v[194:195], v[248:249] op_sel_hi:[1,0]
  v_pk_mul_f32 v[196:197], v[196:197], v[248:249] op_sel_hi:[1,0]
  v_pk_mul_f32 v[198:199], v[198:199], v[248:249] op_sel_hi:[1,0]
  v_cvt_pk_bf16_f32 v64, v184, v185
  v_cvt_pk_bf16_f32 v65, v186, v187
  v_cvt_pk_bf16_f32 v66, v188, v189
  v_cvt_pk_bf16_f32 v67, v190, v191
  v_cvt_pk_bf16_f32 v68, v192, v193
  v_cvt_pk_bf16_f32 v69, v194, v195
  v_cvt_pk_bf16_f32 v70, v196, v197
  v_cvt_pk_bf16_f32 v71, v198, v199
  v_bfi_b32 v71, v242, s44, v71
  s_mul_i32 s46, s48, 6144
  v_add_u32 v115, s46, v108
  v_add_u32 v114, s46, v236
  s_waitcnt vmcnt(0)
  ds_read_b64_tr_b16 v[0:1], v115 offset:0
  ds_read_b64_tr_b16 v[2:3], v115 offset:256
  ds_read_b64_tr_b16 v[4:5], v115 offset:1024
  ds_read_b64_tr_b16 v[6:7], v115 offset:1280
  ds_read_b64_tr_b16 v[8:9], v115 offset:2048
  ds_read_b64_tr_b16 v[10:11], v115 offset:2304
  ds_read_b64_tr_b16 v[12:13], v115 offset:3072
  ds_read_b64_tr_b16 v[14:15], v115 offset:3328
  ds_read_b64_tr_b16 v[16:17], v115 offset:4096
  ds_read_b64_tr_b16 v[18:19], v115 offset:4352
  ds_read_b64_tr_b16 v[20:21], v115 offset:5120
  ds_read_b64_tr_b16 v[22:23], v115 offset:5376
  s_mov_b32 s47, 0x3f803f80
  s_mov_b32 s46, 0x00003f80
  v_mov_b32 v113, 0
  v_mov_b32 v116, 0
  v_lshlrev_b32 v117, 16, v110
  v_mul_f32 v117, 0x3ef00000, v117
  v_cvt_pk_bf16_f32 v117, v117, v117
  v_lshlrev_b32 v117, 16, v117
  s_waitcnt lgkmcnt(10)
  v_dot2_f32_bf16 v113, v0, s47, v113
  v_dot2_f32_bf16 v116, v1, s47, v116
  v_dot2_f32_bf16 v113, v2, s47, v113
  v_dot2_f32_bf16 v116, v3, s47, v116
  s_waitcnt lgkmcnt(8)
  v_dot2_f32_bf16 v113, v4, s47, v113
  v_dot2_f32_bf16 v116, v5, s47, v116
  v_dot2_f32_bf16 v113, v6, s47, v113
  v_dot2_f32_bf16 v116, v7, s47, v116
  s_waitcnt lgkmcnt(6)
  v_dot2_f32_bf16 v113, v8, s47, v113
  v_dot2_f32_bf16 v116, v9, s47, v116
  v_dot2_f32_bf16 v113, v10, s47, v113
  v_dot2_f32_bf16 v116, v11, s47, v116
  s_waitcnt lgkmcnt(4)
  v_dot2_f32_bf16 v113, v12, s47, v113
  v_dot2_f32_bf16 v116, v13, s47, v116
  v_dot2_f32_bf16 v113, v14, s47, v113
  v_dot2_f32_bf16 v116, v15, s47, v116
  s_waitcnt lgkmcnt(2)
  v_dot2_f32_bf16 v113, v16, s47, v113
  v_dot2_f32_bf16 v116, v17, s47, v116
  v_dot2_f32_bf16 v113, v18, s47, v113
  v_dot2_f32_bf16 v116, v19, s47, v116
  s_waitcnt lgkmcnt(0)
  v_dot2_f32_bf16 v113, v20, s47, v113
  v_dot2_f32_bf16 v116, v21, s47, v116
  v_dot2_f32_bf16 v113, v22, s47, v113
  v_dot2_f32_bf16 v116, v23, s47, v116
  s_mov_b32 s47, 0x3f800000
  s_nop 2
  v_add_f32 v113, v113, v116
  s_nop 0
  v_mov_b32 v116, v113
  s_nop 1
  v_permlane32_swap_b32 v113, v116
  s_nop 1
  v_add_f32 v113, v113, v116
  v_mul_f32 v113, 0xbc2aaaab, v113
  v_dot2_f32_bf16 v72, v0, s46, v113
  v_dot2_f32_bf16 v73, v0, s47, v113
  v_dot2_f32_bf16 v74, v1, s46, v113
  v_dot2_f32_bf16 v75, v1, s47, v113
  v_dot2_f32_bf16 v76, v2, s46, v113
  v_dot2_f32_bf16 v77, v2, s47, v113
  v_dot2_f32_bf16 v78, v3, s46, v113
  v_dot2_f32_bf16 v79, v3, s47, v113
  v_dot2_f32_bf16 v80, v4, s46, v113
  v_dot2_f32_bf16 v81, v4, s47, v113
  v_dot2_f32_bf16 v82, v5, s46, v113
  v_dot2_f32_bf16 v83, v5, s47, v113
  v_dot2_f32_bf16 v84, v6, s46, v113
  v_dot2_f32_bf16 v85, v6, s47, v113
  v_dot2_f32_bf16 v86, v7, s46, v113
  v_dot2_f32_bf16 v87, v7, s47, v113
  v_cvt_pk_bf16_f32 v0, v72, v73
  v_cvt_pk_bf16_f32 v1, v74, v75
  v_cvt_pk_bf16_f32 v2, v76, v77
  v_cvt_pk_bf16_f32 v3, v78, v79
  v_dot2_f32_bf16 v72, v8, s46, v113
  v_dot2_f32_bf16 v73, v8, s47, v113
  v_dot2_f32_bf16 v74, v9, s46, v113
  v_dot2_f32_bf16 v75, v9, s47, v113
  v_dot2_f32_bf16 v76, v10, s46, v113
  v_dot2_f32_bf16 v77, v10, s47, v113
  v_dot2_f32_bf16 v78, v11, s46, v113
  v_dot2_f32_bf16 v79, v11, s47, v113
  v_cvt_pk_bf16_f32 v4, v80, v81
  v_cvt_pk_bf16_f32 v5, v82, v83
  v_cvt_pk_bf16_f32 v6, v84, v85
  v_cvt_pk_bf16_f32 v7, v86, v87
  ds_write_b128 v114, v[4:7] offset:1024
  v_dot2_f32_bf16 v80, v12, s46, v113
  v_dot2_f32_bf16 v81, v12, s47, v113
  v_dot2_f32_bf16 v82, v13, s46, v113
  v_dot2_f32_bf16 v83, v13, s47, v113
  v_dot2_f32_bf16 v84, v14, s46, v113
  v_dot2_f32_bf16 v85, v14, s47, v113
  v_dot2_f32_bf16 v86, v15, s46, v113
  v_dot2_f32_bf16 v87, v15, s47, v113
  v_cvt_pk_bf16_f32 v8, v72, v73
  v_cvt_pk_bf16_f32 v9, v74, v75
  v_cvt_pk_bf16_f32 v10, v76, v77
  v_cvt_pk_bf16_f32 v11, v78, v79
  ds_write_b128 v114, v[8:11] offset:2048
  v_dot2_f32_bf16 v72, v16, s46, v113
  v_dot2_f32_bf16 v73, v16, s47, v113
  v_dot2_f32_bf16 v74, v17, s46, v113
  v_dot2_f32_bf16 v75, v17, s47, v113
  v_dot2_f32_bf16 v76, v18, s46, v113
  v_dot2_f32_bf16 v77, v18, s47, v113
  v_dot2_f32_bf16 v78, v19, s46, v113
  v_dot2_f32_bf16 v79, v19, s47, v113
  v_cvt_pk_bf16_f32 v12, v80, v81
  v_cvt_pk_bf16_f32 v13, v82, v83
  v_cvt_pk_bf16_f32 v14, v84, v85
  v_cvt_pk_bf16_f32 v15, v86, v87
  ds_write_b128 v114, v[12:15] offset:3072
  v_dot2_f32_bf16 v80, v20, s46, v113
  v_dot2_f32_bf16 v81, v20, s47, v113
  v_dot2_f32_bf16 v82, v21, s46, v113
  v_dot2_f32_bf16 v83, v21, s47, v113
  v_dot2_f32_bf16 v84, v22, s46, v113
  v_dot2_f32_bf16 v85, v22, s47, v113
  v_dot2_f32_bf16 v86, v23, s46, v113
  v_dot2_f32_bf16 v87, v23, s47, v113
  v_cvt_pk_bf16_f32 v16, v72, v73
  v_cvt_pk_bf16_f32 v17, v74, v75
  v_cvt_pk_bf16_f32 v18, v76, v77
  v_cvt_pk_bf16_f32 v19, v78, v79
  ds_write_b128 v114, v[16:19] offset:4096
  s_nop 2
  v_cvt_pk_bf16_f32 v20, v80, v81
  v_cvt_pk_bf16_f32 v21, v82, v83
  v_cvt_pk_bf16_f32 v22, v84, v85
  v_cvt_pk_bf16_f32 v23, v86, v87
  ds_write_b128 v114, v[0:3] offset:0
  v_bfi_b32 v23, v242, v117, v23
  s_nop 0
  ds_write_b128 v114, v[20:23] offset:5120
  s_waitcnt lgkmcnt(0)
  s_barrier
  s_setprio 2
  s_mov_b32 s47, 2
  s_branch L_pro_done
L_grpB:
  s_add_u32 s48, s45, 0
  s_add_u32 s49, s45, 4
  s_add_u32 s50, s45, 4
  s_add_u32 s51, s45, 8
  s_add_u32 s52, s45, 8
  s_mul_i32 s45, s48, 6144
  s_add_u32 s46, s45, 73728
  s_mov_b32 m0, s46
  s_add_u32 s47, s45, 0
  s_nop 0
  buffer_load_dwordx4 v236, s[32:35], s47 offen lds
  s_add_u32 s46, s45, 74752
  s_mov_b32 m0, s46
  s_add_u32 s47, s45, 1024
  s_nop 0
  buffer_load_dwordx4 v236, s[32:35], s47 offen lds
  s_add_u32 s46, s45, 75776
  s_mov_b32 m0, s46
  s_add_u32 s47, s45, 2048
  s_nop 0
  buffer_load_dwordx4 v236, s[32:35], s47 offen lds
  s_add_u32 s46, s45, 76800
  s_mov_b32 m0, s46
  s_add_u32 s47, s45, 3072
  s_nop 0
  buffer_load_dwordx4 v236, s[32:35], s47 offen lds
  s_add_u32 s46, s45, 77824
  s_mov_b32 m0, s46
  s_add_u32 s47, s45, 4096
  s_nop 0
  buffer_load_dwordx4 v236, s[32:35], s47 offen lds
  s_add_u32 s46, s45, 78848
  s_mov_b32 m0, s46
  s_add_u32 s47, s45, 5120
  s_nop 0
  buffer_load_dwordx4 v236, s[32:35], s47 offen lds
  s_waitcnt vmcnt(6)
  v_lshlrev_b32 v115, 1, v107
  v_add_u32 v115, 147456, v115
  v_mov_b32 v114, 147456
  ds_read_u16 v64, v115 offset:0
  ds_read_u16 v65, v115 offset:64
  ds_read_u16 v66, v115 offset:128
  ds_read_u16 v235, v114 offset:190
  s_lshl_b32 s46, s49, 6
  v_add_u32 v116, s46, v115
  ds_read_u16 v111, v116 offset:1152
  s_lshl_b32 s46, s51, 6
  v_add_u32 v116, s46, v115
  ds_read_u16 v112, v116 offset:1152
  ds_read_u16 v67, v115 offset:640
  ds_read_u16 v68, v115 offset:704
  ds_read_u16 v69, v115 offset:768
  v_and_b32 v118, 7, v104
  v_and_b32 v116, 8, v104
  v_lshl_add_u32 v118, v116, 1, v118
  v_and_b32 v116, 16, v104
  v_lshrrev_b32 v116, 1, v116
  v_add_u32 v118, v118, v116
  v_lshlrev_b32 v118, 1, v118
  v_add_u32 v118, 147456, v118
  v_lshl_add_u32 v117, v106, 6, v118
  ds_read_u16 v127, v117 offset:640
  ds_read_u16 v128, v117 offset:896
  ds_read_u16 v129, v118 offset:768
  ds_read_u16 v130, v118 offset:1024
  v_lshrrev_b32 v115, 2, v105
  v_and_b32 v115, 1, v115
  v_and_b32 v116, 7, v107
  v_and_b32 v117, 1, v116
  v_lshlrev_b32 v117, 4, v117
  v_mov_b32 v118, 0xffff
  v_lshlrev_b32 v70, v117, v118
  v_mov_b32 v71, 1
  v_lshrrev_b32 v116, 1, v116
  v_lshrrev_b32 v117, 4, v105
  v_lshl_add_u32 v116, v117, 2, v116
  v_xor_b32 v115, v115, v106
  v_lshl_add_u32 v116, v115, 3, v116
  v_lshlrev_b32 v116, v116, v71
  v_bfe_i32 v56, v116, 0, 1
  v_bfe_i32 v57, v116, 1, 1
  v_bfe_i32 v58, v116, 2, 1
  v_bfe_i32 v59, v116, 3, 1
  v_bfe_i32 v60, v116, 4, 1
  v_bfe_i32 v61, v116, 5, 1
  v_bfe_i32 v62, v116, 6, 1
  v_bfe_i32 v63, v116, 7, 1
  v_and_b32 v56, v56, v70
  v_and_b32 v57, v57, v70
  v_and_b32 v58, v58, v70
  v_and_b32 v59, v59, v70
  v_and_b32 v60, v60, v70
  v_and_b32 v61, v61, v70
  v_and_b32 v62, v62, v70
  v_and_b32 v63, v63, v70
  v_and_b32 v115, 1, v104
  v_lshlrev_b32 v115, 3, v115
  v_and_b32 v116, 2, v104
  v_lshl_add_u32 v115, v116, 1, v115
  v_and_b32 v116, 16, v104
  v_add_u32 v115, v115, v116
  v_lshlrev_b32 v115, 1, v115
  v_lshrrev_b32 v116, 2, v104
  v_and_b32 v116, 3, v116
  v_lshl_add_u32 v116, v106, 3, v116
  v_lshl_add_u32 v108, v116, 6, v115
  v_mul_u32_u24 v109, 192, v107
  v_lshl_add_u32 v109, v106, 4, v109
  s_waitcnt lgkmcnt(0)
  v_lshl_or_b32 v115, v67, 16, v67
  v_and_b32 v24, v115, v56
  v_and_b32 v25, v115, v57
  v_and_b32 v26, v115, v58
  v_and_b32 v27, v115, v59
  v_and_b32 v28, v115, v60
  v_and_b32 v29, v115, v61
  v_and_b32 v30, v115, v62
  v_and_b32 v31, v115, v63
  v_lshl_or_b32 v115, v68, 16, v68
  v_and_b32 v32, v115, v56
  v_and_b32 v33, v115, v57
  v_and_b32 v34, v115, v58
  v_and_b32 v35, v115, v59
  v_and_b32 v36, v115, v60
  v_and_b32 v37, v115, v61
  v_and_b32 v38, v115, v62
  v_and_b32 v39, v115, v63
  v_lshl_or_b32 v115, v69, 16, v69
  v_and_b32 v40, v115, v56
  v_and_b32 v41, v115, v57
  v_and_b32 v42, v115, v58
  v_and_b32 v43, v115, v59
  v_and_b32 v44, v115, v60
  v_and_b32 v45, v115, v61
  v_and_b32 v46, v115, v62
  v_and_b32 v47, v115, v63
  v_lshlrev_b32 v127, 16, v127
  v_lshlrev_b32 v128, 16, v128
  v_lshlrev_b32 v129, 16, v129
  v_lshlrev_b32 v130, 16, v130
  v_mul_f32 v127, v127, v128
  v_mul_f32 v129, v129, v130
  v_lshlrev_b32 v115, 2, v104
  v_add_u32 v115, 147712, v115
  ds_write_b32 v115, v127
  v_lshlrev_b32 v115, 2, v105
  v_add_u32 v115, 147968, v115
  ds_write_b32 v115, v129
  s_mul_i32 s46, s48, 6144
  s_add_u32 s46, s46, 73728
  v_add_u32 v115, s46, v109
  v_add_u32 v114, s46, v236
  s_waitcnt vmcnt(0)
  ds_read_b128 v[0:3], v115 offset:0
  ds_read_b128 v[4:7], v115 offset:32
  ds_read_b128 v[8:11], v115 offset:64
  ds_read_b128 v[12:15], v115 offset:96
  ds_read_b128 v[16:19], v115 offset:128
  ds_read_b128 v[20:23], v115 offset:160
  s_waitcnt lgkmcnt(4)
  v_mfma_f32_32x32x16_bf16 v[72:87], v[0:3], v[24:27], 0
  v_mfma_f32_32x32x16_bf16 v[72:87], v[4:7], v[28:31], v[72:87]
  s_waitcnt lgkmcnt(2)
  v_mfma_f32_32x32x16_bf16 v[88:103], v[8:11], v[32:35], 0
  v_mfma_f32_32x32x16_bf16 v[88:103], v[12:15], v[36:39], v[88:103]
  s_waitcnt lgkmcnt(0)
  v_mfma_f32_32x32x16_bf16 v[120:135], v[16:19], v[40:43], 0
  v_mfma_f32_32x32x16_bf16 v[120:135], v[20:23], v[44:47], v[120:135]
  s_nop 7
  v_cvt_pk_f16_f32 v0, v72, v73
  v_cvt_pk_f16_f32 v1, v74, v75
  v_cvt_pk_f16_f32 v2, v76, v77
  v_cvt_pk_f16_f32 v3, v78, v79
  v_cvt_pk_f16_f32 v12, v80, v81
  v_cvt_pk_f16_f32 v13, v82, v83
  v_cvt_pk_f16_f32 v14, v84, v85
  v_cvt_pk_f16_f32 v15, v86, v87
  v_cvt_pk_f16_f32 v4, v88, v89
  v_cvt_pk_f16_f32 v5, v90, v91
  v_cvt_pk_f16_f32 v6, v92, v93
  v_cvt_pk_f16_f32 v7, v94, v95
  v_cvt_pk_f16_f32 v16, v96, v97
  v_cvt_pk_f16_f32 v17, v98, v99
  v_cvt_pk_f16_f32 v18, v100, v101
  v_cvt_pk_f16_f32 v19, v102, v103
  s_nop 7
  v_cvt_pk_f16_f32 v8, v120, v121
  v_cvt_pk_f16_f32 v9, v122, v123
  v_cvt_pk_f16_f32 v10, v124, v125
  v_cvt_pk_f16_f32 v11, v126, v127
  v_cvt_pk_f16_f32 v20, v128, v129
  v_cvt_pk_f16_f32 v21, v130, v131
  v_cvt_pk_f16_f32 v22, v132, v133
  v_cvt_pk_f16_f32 v23, v134, v135
  s_nop 0
  ds_write_b128 v114, v[0:3] offset:0
  ds_write_b128 v114, v[4:7] offset:1024
  ds_write_b128 v114, v[8:11] offset:2048
  ds_write_b128 v114, v[12:15] offset:3072
  ds_write_b128 v114, v[16:19] offset:4096
  ds_write_b128 v114, v[20:23] offset:5120
  s_waitcnt lgkmcnt(0)
  s_barrier
  s_setprio 3
  s_mul_i32 s45, s49, 6144
  s_add_u32 s46, s45, 0
  s_mov_b32 m0, s46
  s_lshl_b32 s47, s49, 6
  s_add_u32 s47, s47, 0
  buffer_load_dwordx4 v119, s[28:31], s47 offen lds
  s_add_u32 s46, s45, 1024
  s_mov_b32 m0, s46
  s_lshl_b32 s47, s49, 6
  s_add_u32 s47, s47, 12288
  buffer_load_dwordx4 v119, s[28:31], s47 offen lds
  s_add_u32 s46, s45, 2048
  s_mov_b32 m0, s46
  s_lshl_b32 s47, s49, 6
  s_add_u32 s47, s47, 24576
  buffer_load_dwordx4 v119, s[28:31], s47 offen lds
  s_add_u32 s46, s45, 3072
  s_mov_b32 m0, s46
  s_lshl_b32 s47, s49, 6
  s_add_u32 s47, s47, 36864
  buffer_load_dwordx4 v119, s[28:31], s47 offen lds
  s_add_u32 s46, s45, 4096
  s_mov_b32 m0, s46
  s_lshl_b32 s47, s49, 6
  s_add_u32 s47, s47, 49152
  buffer_load_dwordx4 v119, s[28:31], s47 offen lds
  s_add_u32 s46, s45, 5120
  s_mov_b32 m0, s46
  s_lshl_b32 s47, s49, 6
  s_add_u32 s47, s47, 61440
  buffer_load_dwordx4 v119, s[28:31], s47 offen lds
  s_mul_i32 s45, s50, 6144
  s_add_u32 s46, s45, 73728
  s_mov_b32 m0, s46
  s_add_u32 s47, s45, 0
  s_nop 0
  buffer_load_dwordx4 v236, s[32:35], s47 offen lds
  s_add_u32 s46, s45, 74752
  s_mov_b32 m0, s46
  s_add_u32 s47, s45, 1024
  s_nop 0
  buffer_load_dwordx4 v236, s[32:35], s47 offen lds
  s_add_u32 s46, s45, 75776
  s_mov_b32 m0, s46
  s_add_u32 s47, s45, 2048
  s_nop 0
  buffer_load_dwordx4 v236, s[32:35], s47 offen lds
  s_add_u32 s46, s45, 76800
  s_mov_b32 m0, s46
  s_add_u32 s47, s45, 3072
  s_nop 0
  buffer_load_dwordx4 v236, s[32:35], s47 offen lds
  s_add_u32 s46, s45, 77824
  s_mov_b32 m0, s46
  s_add_u32 s47, s45, 4096
  s_nop 0
  buffer_load_dwordx4 v236, s[32:35], s47 offen lds
  s_add_u32 s46, s45, 78848
  s_mov_b32 m0, s46
  s_add_u32 s47, s45, 5120
  s_nop 0
  buffer_load_dwordx4 v236, s[32:35], s47 offen lds
  s_mul_i32 s45, s51, 6144
  s_add_u32 s46, s45, 0
  s_mov_b32 m0, s46
  s_lshl_b32 s47, s51, 6
  s_add_u32 s47, s47, 0
  buffer_load_dwordx4 v119, s[28:31], s47 offen lds
  s_add_u32 s46, s45, 1024
  s_mov_b32 m0, s46
  s_lshl_b32 s47, s51, 6
  s_add_u32 s47, s47, 12288
  buffer_load_dwordx4 v119, s[28:31], s47 offen lds
  s_add_u32 s46, s45, 2048
  s_mov_b32 m0, s46
  s_lshl_b32 s47, s51, 6
  s_add_u32 s47, s47, 24576
  buffer_load_dwordx4 v119, s[28:31], s47 offen lds
  s_add_u32 s46, s45, 3072
  s_mov_b32 m0, s46
  s_lshl_b32 s47, s51, 6
  s_add_u32 s47, s47, 36864
  buffer_load_dwordx4 v119, s[28:31], s47 offen lds
  s_add_u32 s46, s45, 4096
  s_mov_b32 m0, s46
  s_lshl_b32 s47, s51, 6
  s_add_u32 s47, s47, 49152
  buffer_load_dwordx4 v119, s[28:31], s47 offen lds
  s_add_u32 s46, s45, 5120
  s_mov_b32 m0, s46
  s_lshl_b32 s47, s51, 6
  s_add_u32 s47, s47, 61440
  buffer_load_dwordx4 v119, s[28:31], s47 offen lds
  v_lshl_or_b32 v115, v64, 16, v64
  v_and_b32 v200, v115, v56
  v_and_b32 v201, v115, v57
  v_and_b32 v202, v115, v58
  v_and_b32 v203, v115, v59
  v_and_b32 v204, v115, v60
  v_and_b32 v205, v115, v61
  v_and_b32 v206, v115, v62
  v_and_b32 v207, v115, v63
  v_lshl_or_b32 v115, v65, 16, v65
  v_and_b32 v208, v115, v56
  v_and_b32 v209, v115, v57
  v_and_b32 v210, v115, v58
  v_and_b32 v211, v115, v59
  v_and_b32 v212, v115, v60
  v_and_b32 v213, v115, v61
  v_and_b32 v214, v115, v62
  v_and_b32 v215, v115, v63
  v_lshl_or_b32 v115, v66, 16, v66
  v_and_b32 v216, v115, v56
  v_and_b32 v217, v115, v57
  v_and_b32 v218, v115, v58
  v_and_b32 v219, v115, v59
  v_and_b32 v220, v115, v60
  v_and_b32 v221, v115, v61
  v_and_b32 v222, v115, v62
  v_and_b32 v223, v115, v63
  v_mov_b32 v232, 0
  v_mov_b32 v233, 0
  v_mov_b32 v234, 0
  v_xor_b32 v235, 0x8000, v235
  v_lshlrev_b32 v235, 16, v235
  v_and_b32 v235, v235, v242
  v_and_b32 v224, 0x3f803f80, v56
  v_and_b32 v225, 0x3f803f80, v57
  v_and_b32 v226, 0x3f803f80, v58
  v_and_b32 v227, 0x3f803f80, v59
  v_and_b32 v228, 0x3f803f80, v60
  v_and_b32 v229, 0x3f803f80, v61
  v_and_b32 v230, 0x3f803f80, v62
  v_and_b32 v231, 0x3f803f80, v63
  s_mul_i32 s46, s49, 6144
  v_add_u32 v115, s46, v108
  v_add_u32 v114, s46, v236
  s_waitcnt vmcnt(12)
  ds_read_b64_tr_b16 v[0:1], v115 offset:0
  ds_read_b64_tr_b16 v[2:3], v115 offset:256
  ds_read_b64_tr_b16 v[4:5], v115 offset:1024
  ds_read_b64_tr_b16 v[6:7], v115 offset:1280
  ds_read_b64_tr_b16 v[8:9], v115 offset:2048
  ds_read_b64_tr_b16 v[10:11], v115 offset:2304
  ds_read_b64_tr_b16 v[12:13], v115 offset:3072
  ds_read_b64_tr_b16 v[14:15], v115 offset:3328
  ds_read_b64_tr_b16 v[16:17], v115 offset:4096
  ds_read_b64_tr_b16 v[18:19], v115 offset:4352
  ds_read_b64_tr_b16 v[20:21], v115 offset:5120
  ds_read_b64_tr_b16 v[22:23], v115 offset:5376
  s_mov_b32 s47, 0x3f803f80
  s_mov_b32 s46, 0x00003f80
  v_mov_b32 v113, 0
  v_mov_b32 v116, 0
  v_lshlrev_b32 v117, 16, v111
  v_mul_f32 v117, 0x3ef00000, v117
  v_cvt_pk_bf16_f32 v117, v117, v117
  v_lshlrev_b32 v117, 16, v117
  s_waitcnt lgkmcnt(10)
  v_dot2_f32_bf16 v113, v0, s47, v113
  v_dot2_f32_bf16 v116, v1, s47, v116
  v_dot2_f32_bf16 v113, v2, s47, v113
  v_dot2_f32_bf16 v116, v3, s47, v116
  s_waitcnt lgkmcnt(8)
  v_dot2_f32_bf16 v113, v4, s47, v113
  v_dot2_f32_bf16 v116, v5, s47, v116
  v_dot2_f32_bf16 v113, v6, s47, v113
  v_dot2_f32_bf16 v116, v7, s47, v116
  s_waitcnt lgkmcnt(6)
  v_dot2_f32_bf16 v113, v8, s47, v113
  v_dot2_f32_bf16 v116, v9, s47, v116
  v_dot2_f32_bf16 v113, v10, s47, v113
  v_dot2_f32_bf16 v116, v11, s47, v116
  s_waitcnt lgkmcnt(4)
  v_dot2_f32_bf16 v113, v12, s47, v113
  v_dot2_f32_bf16 v116, v13, s47, v116
  v_dot2_f32_bf16 v113, v14, s47, v113
  v_dot2_f32_bf16 v116, v15, s47, v116
  s_waitcnt lgkmcnt(2)
  v_dot2_f32_bf16 v113, v16, s47, v113
  v_dot2_f32_bf16 v116, v17, s47, v116
  v_dot2_f32_bf16 v113, v18, s47, v113
  v_dot2_f32_bf16 v116, v19, s47, v116
  s_waitcnt lgkmcnt(0)
  v_dot2_f32_bf16 v113, v20, s47, v113
  v_dot2_f32_bf16 v116, v21, s47, v116
  v_dot2_f32_bf16 v113, v22, s47, v113
  v_dot2_f32_bf16 v116, v23, s47, v116
  s_mov_b32 s47, 0x3f800000
  s_nop 2
  v_add_f32 v113, v113, v116
  s_nop 0
  v_mov_b32 v116, v113
  s_nop 1
  v_permlane32_swap_b32 v113, v116
  s_nop 1
  v_add_f32 v113, v113, v116
  v_mul_f32 v113, 0xbc2aaaab, v113
  v_dot2_f32_bf16 v72, v0, s46, v113
  v_dot2_f32_bf16 v73, v0, s47, v113
  v_dot2_f32_bf16 v74, v1, s46, v113
  v_dot2_f32_bf16 v75, v1, s47, v113
  v_dot2_f32_bf16 v76, v2, s46, v113
  v_dot2_f32_bf16 v77, v2, s47, v113
  v_dot2_f32_bf16 v78, v3, s46, v113
  v_dot2_f32_bf16 v79, v3, s47, v113
  v_dot2_f32_bf16 v80, v4, s46, v113
  v_dot2_f32_bf16 v81, v4, s47, v113
  v_dot2_f32_bf16 v82, v5, s46, v113
  v_dot2_f32_bf16 v83, v5, s47, v113
  v_dot2_f32_bf16 v84, v6, s46, v113
  v_dot2_f32_bf16 v85, v6, s47, v113
  v_dot2_f32_bf16 v86, v7, s46, v113
  v_dot2_f32_bf16 v87, v7, s47, v113
  v_cvt_pk_bf16_f32 v0, v72, v73
  v_cvt_pk_bf16_f32 v1, v74, v75
  v_cvt_pk_bf16_f32 v2, v76, v77
  v_cvt_pk_bf16_f32 v3, v78, v79
  v_dot2_f32_bf16 v72, v8, s46, v113
  v_dot2_f32_bf16 v73, v8, s47, v113
  v_dot2_f32_bf16 v74, v9, s46, v113
  v_dot2_f32_bf16 v75, v9, s47, v113
  v_dot2_f32_bf16 v76, v10, s46, v113
  v_dot2_f32_bf16 v77, v10, s47, v113
  v_dot2_f32_bf16 v78, v11, s46, v113
  v_dot2_f32_bf16 v79, v11, s47, v113
  v_cvt_pk_bf16_f32 v4, v80, v81
  v_cvt_pk_bf16_f32 v5, v82, v83
  v_cvt_pk_bf16_f32 v6, v84, v85
  v_cvt_pk_bf16_f32 v7, v86, v87
  ds_write_b128 v114, v[4:7] offset:1024
  v_dot2_f32_bf16 v80, v12, s46, v113
  v_dot2_f32_bf16 v81, v12, s47, v113
  v_dot2_f32_bf16 v82, v13, s46, v113
  v_dot2_f32_bf16 v83, v13, s47, v113
  v_dot2_f32_bf16 v84, v14, s46, v113
  v_dot2_f32_bf16 v85, v14, s47, v113
  v_dot2_f32_bf16 v86, v15, s46, v113
  v_dot2_f32_bf16 v87, v15, s47, v113
  v_cvt_pk_bf16_f32 v8, v72, v73
  v_cvt_pk_bf16_f32 v9, v74, v75
  v_cvt_pk_bf16_f32 v10, v76, v77
  v_cvt_pk_bf16_f32 v11, v78, v79
  ds_write_b128 v114, v[8:11] offset:2048
  v_dot2_f32_bf16 v72, v16, s46, v113
  v_dot2_f32_bf16 v73, v16, s47, v113
  v_dot2_f32_bf16 v74, v17, s46, v113
  v_dot2_f32_bf16 v75, v17, s47, v113
  v_dot2_f32_bf16 v76, v18, s46, v113
  v_dot2_f32_bf16 v77, v18, s47, v113
  v_dot2_f32_bf16 v78, v19, s46, v113
  v_dot2_f32_bf16 v79, v19, s47, v113
  v_cvt_pk_bf16_f32 v12, v80, v81
  v_cvt_pk_bf16_f32 v13, v82, v83
  v_cvt_pk_bf16_f32 v14, v84, v85
  v_cvt_pk_bf16_f32 v15, v86, v87
  ds_write_b128 v114, v[12:15] offset:3072
  v_dot2_f32_bf16 v80, v20, s46, v113
  v_dot2_f32_bf16 v81, v20, s47, v113
  v_dot2_f32_bf16 v82, v21, s46, v113
  v_dot2_f32_bf16 v83, v21, s47, v113
  v_dot2_f32_bf16 v84, v22, s46, v113
  v_dot2_f32_bf16 v85, v22, s47, v113
  v_dot2_f32_bf16 v86, v23, s46, v113
  v_dot2_f32_bf16 v87, v23, s47, v113
  v_cvt_pk_bf16_f32 v16, v72, v73
  v_cvt_pk_bf16_f32 v17, v74, v75
  v_cvt_pk_bf16_f32 v18, v76, v77
  v_cvt_pk_bf16_f32 v19, v78, v79
  ds_write_b128 v114, v[16:19] offset:4096
  s_nop 2
  v_cvt_pk_bf16_f32 v20, v80, v81
  v_cvt_pk_bf16_f32 v21, v82, v83
  v_cvt_pk_bf16_f32 v22, v84, v85
  v_cvt_pk_bf16_f32 v23, v86, v87
  ds_write_b128 v114, v[0:3] offset:0
  v_bfi_b32 v23, v242, v117, v23
  s_nop 0
  ds_write_b128 v114, v[20:23] offset:5120
  s_waitcnt lgkmcnt(0)
  s_mul_i32 s46, s50, 6144
  s_add_u32 s46, s46, 73728
  v_add_u32 v115, s46, v109
  v_add_u32 v114, s46, v236
  s_waitcnt vmcnt(6)
  ds_read_b128 v[0:3], v115 offset:0
  ds_read_b128 v[4:7], v115 offset:32
  ds_read_b128 v[8:11], v115 offset:64
  ds_read_b128 v[12:15], v115 offset:96
  ds_read_b128 v[16:19], v115 offset:128
  ds_read_b128 v[20:23], v115 offset:160
  s_waitcnt lgkmcnt(4)
  v_mfma_f32_32x32x16_bf16 v[72:87], v[0:3], v[24:27], 0
  v_mfma_f32_32x32x16_bf16 v[72:87], v[4:7], v[28:31], v[72:87]
  s_waitcnt lgkmcnt(2)
  v_mfma_f32_32x32x16_bf16 v[88:103], v[8:11], v[32:35], 0
  v_mfma_f32_32x32x16_bf16 v[88:103], v[12:15], v[36:39], v[88:103]
  s_waitcnt lgkmcnt(0)
  v_mfma_f32_32x32x16_bf16 v[120:135], v[16:19], v[40:43], 0
  v_mfma_f32_32x32x16_bf16 v[120:135], v[20:23], v[44:47], v[120:135]
  s_nop 7
  v_cvt_pk_f16_f32 v0, v72, v73
  v_cvt_pk_f16_f32 v1, v74, v75
  v_cvt_pk_f16_f32 v2, v76, v77
  v_cvt_pk_f16_f32 v3, v78, v79
  v_cvt_pk_f16_f32 v12, v80, v81
  v_cvt_pk_f16_f32 v13, v82, v83
  v_cvt_pk_f16_f32 v14, v84, v85
  v_cvt_pk_f16_f32 v15, v86, v87
  v_cvt_pk_f16_f32 v4, v88, v89
  v_cvt_pk_f16_f32 v5, v90, v91
  v_cvt_pk_f16_f32 v6, v92, v93
  v_cvt_pk_f16_f32 v7, v94, v95
  v_cvt_pk_f16_f32 v16, v96, v97
  v_cvt_pk_f16_f32 v17, v98, v99
  v_cvt_pk_f16_f32 v18, v100, v101
  v_cvt_pk_f16_f32 v19, v102, v103
  s_nop 7
  v_cvt_pk_f16_f32 v8, v120, v121
  v_cvt_pk_f16_f32 v9, v122, v123
  v_cvt_pk_f16_f32 v10, v124, v125
  v_cvt_pk_f16_f32 v11, v126, v127
  v_cvt_pk_f16_f32 v20, v128, v129
  v_cvt_pk_f16_f32 v21, v130, v131
  v_cvt_pk_f16_f32 v22, v132, v133
  v_cvt_pk_f16_f32 v23, v134, v135
  s_nop 0
  ds_write_b128 v114, v[0:3] offset:0
  ds_write_b128 v114, v[4:7] offset:1024
  ds_write_b128 v114, v[8:11] offset:2048
  ds_write_b128 v114, v[12:15] offset:3072
  ds_write_b128 v114, v[16:19] offset:4096
  ds_write_b128 v114, v[20:23] offset:5120
  s_waitcnt lgkmcnt(0)
  s_barrier
  s_mul_i32 s45, s52, 6144
  s_add_u32 s46, s45, 73728
  s_mov_b32 m0, s46
  s_add_u32 s47, s45, 0
  s_nop 0
  buffer_load_dwordx4 v236, s[32:35], s47 offen lds
  s_add_u32 s46, s45, 74752
  s_mov_b32 m0, s46
  s_add_u32 s47, s45, 1024
  s_nop 0
  buffer_load_dwordx4 v236, s[32:35], s47 offen lds
  s_add_u32 s46, s45, 75776
  s_mov_b32 m0, s46
  s_add_u32 s47, s45, 2048
  s_nop 0
  buffer_load_dwordx4 v236, s[32:35], s47 offen lds
  s_add_u32 s46, s45, 76800
  s_mov_b32 m0, s46
  s_add_u32 s47, s45, 3072
  s_nop 0
  buffer_load_dwordx4 v236, s[32:35], s47 offen lds
  s_add_u32 s46, s45, 77824
  s_mov_b32 m0, s46
  s_add_u32 s47, s45, 4096
  s_nop 0
  buffer_load_dwordx4 v236, s[32:35], s47 offen lds
  s_add_u32 s46, s45, 78848
  s_mov_b32 m0, s46
  s_add_u32 s47, s45, 5120
  s_nop 0
  buffer_load_dwordx4 v236, s[32:35], s47 offen lds
  buffer_load_dwordx4 v[160:163], v250, s[20:23], 0 offen offset:0
  buffer_load_dwordx4 v[164:167], v250, s[20:23], 0 offen offset:32
  buffer_load_dwordx4 v[168:171], v250, s[20:23], 0 offen offset:64
  buffer_load_dwordx4 v[172:175], v250, s[20:23], 0 offen offset:96
  buffer_load_dwordx4 v[176:179], v250, s[20:23], 0 offen offset:128
  buffer_load_dwordx4 v[180:183], v250, s[20:23], 0 offen offset:160
  s_mul_i32 s46, s51, 6144
  v_add_u32 v115, s46, v108
  v_add_u32 v114, s46, v236
  s_waitcnt vmcnt(12)
  ds_read_b64_tr_b16 v[0:1], v115 offset:0
  ds_read_b64_tr_b16 v[2:3], v115 offset:256
  ds_read_b64_tr_b16 v[4:5], v115 offset:1024
  ds_read_b64_tr_b16 v[6:7], v115 offset:1280
  ds_read_b64_tr_b16 v[8:9], v115 offset:2048
  ds_read_b64_tr_b16 v[10:11], v115 offset:2304
  ds_read_b64_tr_b16 v[12:13], v115 offset:3072
  ds_read_b64_tr_b16 v[14:15], v115 offset:3328
  ds_read_b64_tr_b16 v[16:17], v115 offset:4096
  ds_read_b64_tr_b16 v[18:19], v115 offset:4352
  ds_read_b64_tr_b16 v[20:21], v115 offset:5120
  ds_read_b64_tr_b16 v[22:23], v115 offset:5376
  s_mov_b32 s47, 0x3f803f80
  s_mov_b32 s46, 0x00003f80
  v_mov_b32 v113, 0
  v_mov_b32 v116, 0
  v_lshlrev_b32 v117, 16, v112
  v_mul_f32 v117, 0x3ef00000, v117
  v_cvt_pk_bf16_f32 v117, v117, v117
  v_lshlrev_b32 v117, 16, v117
  s_waitcnt lgkmcnt(10)
  v_dot2_f32_bf16 v113, v0, s47, v113
  v_dot2_f32_bf16 v116, v1, s47, v116
  v_dot2_f32_bf16 v113, v2, s47, v113
  v_dot2_f32_bf16 v116, v3, s47, v116
  s_waitcnt lgkmcnt(8)
  v_dot2_f32_bf16 v113, v4, s47, v113
  v_dot2_f32_bf16 v116, v5, s47, v116
  v_dot2_f32_bf16 v113, v6, s47, v113
  v_dot2_f32_bf16 v116, v7, s47, v116
  s_waitcnt lgkmcnt(6)
  v_dot2_f32_bf16 v113, v8, s47, v113
  v_dot2_f32_bf16 v116, v9, s47, v116
  v_dot2_f32_bf16 v113, v10, s47, v113
  v_dot2_f32_bf16 v116, v11, s47, v116
  s_waitcnt lgkmcnt(4)
  v_dot2_f32_bf16 v113, v12, s47, v113
  v_dot2_f32_bf16 v116, v13, s47, v116
  v_dot2_f32_bf16 v113, v14, s47, v113
  v_dot2_f32_bf16 v116, v15, s47, v116
  s_waitcnt lgkmcnt(2)
  v_dot2_f32_bf16 v113, v16, s47, v113
  v_dot2_f32_bf16 v116, v17, s47, v116
  v_dot2_f32_bf16 v113, v18, s47, v113
  v_dot2_f32_bf16 v116, v19, s47, v116
  s_waitcnt lgkmcnt(0)
  v_dot2_f32_bf16 v113, v20, s47, v113
  v_dot2_f32_bf16 v116, v21, s47, v116
  v_dot2_f32_bf16 v113, v22, s47, v113
  v_dot2_f32_bf16 v116, v23, s47, v116
  s_mov_b32 s47, 0x3f800000
  s_nop 2
  v_add_f32 v113, v113, v116
  s_nop 0
  v_mov_b32 v116, v113
  s_nop 1
  v_permlane32_swap_b32 v113, v116
  s_nop 1
  v_add_f32 v113, v113, v116
  v_mul_f32 v113, 0xbc2aaaab, v113
  v_dot2_f32_bf16 v72, v0, s46, v113
  v_dot2_f32_bf16 v73, v0, s47, v113
  v_dot2_f32_bf16 v74, v1, s46, v113
  v_dot2_f32_bf16 v75, v1, s47, v113
  v_dot2_f32_bf16 v76, v2, s46, v113
  v_dot2_f32_bf16 v77, v2, s47, v113
  v_dot2_f32_bf16 v78, v3, s46, v113
  v_dot2_f32_bf16 v79, v3, s47, v113
  v_dot2_f32_bf16 v80, v4, s46, v113
  v_dot2_f32_bf16 v81, v4, s47, v113
  v_dot2_f32_bf16 v82, v5, s46, v113
  v_dot2_f32_bf16 v83, v5, s47, v113
  v_dot2_f32_bf16 v84, v6, s46, v113
  v_dot2_f32_bf16 v85, v6, s47, v113
  v_dot2_f32_bf16 v86, v7, s46, v113
  v_dot2_f32_bf16 v87, v7, s47, v113
  v_cvt_pk_bf16_f32 v0, v72, v73
  v_cvt_pk_bf16_f32 v1, v74, v75
  v_cvt_pk_bf16_f32 v2, v76, v77
  v_cvt_pk_bf16_f32 v3, v78, v79
  v_dot2_f32_bf16 v72, v8, s46, v113
  v_dot2_f32_bf16 v73, v8, s47, v113
  v_dot2_f32_bf16 v74, v9, s46, v113
  v_dot2_f32_bf16 v75, v9, s47, v113
  v_dot2_f32_bf16 v76, v10, s46, v113
  v_dot2_f32_bf16 v77, v10, s47, v113
  v_dot2_f32_bf16 v78, v11, s46, v113
  v_dot2_f32_bf16 v79, v11, s47, v113
  v_cvt_pk_bf16_f32 v4, v80, v81
  v_cvt_pk_bf16_f32 v5, v82, v83
  v_cvt_pk_bf16_f32 v6, v84, v85
  v_cvt_pk_bf16_f32 v7, v86, v87
  ds_write_b128 v114, v[4:7] offset:1024
  v_dot2_f32_bf16 v80, v12, s46, v113
  v_dot2_f32_bf16 v81, v12, s47, v113
  v_dot2_f32_bf16 v82, v13, s46, v113
  v_dot2_f32_bf16 v83, v13, s47, v113
  v_dot2_f32_bf16 v84, v14, s46, v113
  v_dot2_f32_bf16 v85, v14, s47, v113
  v_dot2_f32_bf16 v86, v15, s46, v113
  v_dot2_f32_bf16 v87, v15, s47, v113
  v_cvt_pk_bf16_f32 v8, v72, v73
  v_cvt_pk_bf16_f32 v9, v74, v75
  v_cvt_pk_bf16_f32 v10, v76, v77
  v_cvt_pk_bf16_f32 v11, v78, v79
  ds_write_b128 v114, v[8:11] offset:2048
  v_dot2_f32_bf16 v72, v16, s46, v113
  v_dot2_f32_bf16 v73, v16, s47, v113
  v_dot2_f32_bf16 v74, v17, s46, v113
  v_dot2_f32_bf16 v75, v17, s47, v113
  v_dot2_f32_bf16 v76, v18, s46, v113
  v_dot2_f32_bf16 v77, v18, s47, v113
  v_dot2_f32_bf16 v78, v19, s46, v113
  v_dot2_f32_bf16 v79, v19, s47, v113
  v_cvt_pk_bf16_f32 v12, v80, v81
  v_cvt_pk_bf16_f32 v13, v82, v83
  v_cvt_pk_bf16_f32 v14, v84, v85
  v_cvt_pk_bf16_f32 v15, v86, v87
  ds_write_b128 v114, v[12:15] offset:3072
  v_dot2_f32_bf16 v80, v20, s46, v113
  v_dot2_f32_bf16 v81, v20, s47, v113
  v_dot2_f32_bf16 v82, v21, s46, v113
  v_dot2_f32_bf16 v83, v21, s47, v113
  v_dot2_f32_bf16 v84, v22, s46, v113
  v_dot2_f32_bf16 v85, v22, s47, v113
  v_dot2_f32_bf16 v86, v23, s46, v113
  v_dot2_f32_bf16 v87, v23, s47, v113
  v_cvt_pk_bf16_f32 v16, v72, v73
  v_cvt_pk_bf16_f32 v17, v74, v75
  v_cvt_pk_bf16_f32 v18, v76, v77
  v_cvt_pk_bf16_f32 v19, v78, v79
  ds_write_b128 v114, v[16:19] offset:4096
  s_nop 2
  v_cvt_pk_bf16_f32 v20, v80, v81
  v_cvt_pk_bf16_f32 v21, v82, v83
  v_cvt_pk_bf16_f32 v22, v84, v85
  v_cvt_pk_bf16_f32 v23, v86, v87
  ds_write_b128 v114, v[0:3] offset:0
  v_bfi_b32 v23, v242, v117, v23
  s_nop 0
  ds_write_b128 v114, v[20:23] offset:5120
  s_waitcnt lgkmcnt(0)
  s_mul_i32 s46, s52, 6144
  s_add_u32 s46, s46, 73728
  v_add_u32 v115, s46, v109
  v_add_u32 v114, s46, v236
  s_waitcnt vmcnt(6)
  ds_read_b128 v[0:3], v115 offset:0
  ds_read_b128 v[4:7], v115 offset:32
  ds_read_b128 v[8:11], v115 offset:64
  ds_read_b128 v[12:15], v115 offset:96
  ds_read_b128 v[16:19], v115 offset:128
  ds_read_b128 v[20:23], v115 offset:160
  s_waitcnt lgkmcnt(4)
  v_mfma_f32_32x32x16_bf16 v[72:87], v[0:3], v[24:27], 0
  v_mfma_f32_32x32x16_bf16 v[72:87], v[4:7], v[28:31], v[72:87]
  s_waitcnt lgkmcnt(2)
  v_mfma_f32_32x32x16_bf16 v[88:103], v[8:11], v[32:35], 0
  v_mfma_f32_32x32x16_bf16 v[88:103], v[12:15], v[36:39], v[88:103]
  s_waitcnt lgkmcnt(0)
  v_mfma_f32_32x32x16_bf16 v[120:135], v[16:19], v[40:43], 0
  v_mfma_f32_32x32x16_bf16 v[120:135], v[20:23], v[44:47], v[120:135]
  s_nop 7
  v_cvt_pk_f16_f32 v0, v72, v73
  v_cvt_pk_f16_f32 v1, v74, v75
  v_cvt_pk_f16_f32 v2, v76, v77
  v_cvt_pk_f16_f32 v3, v78, v79
  v_cvt_pk_f16_f32 v12, v80, v81
  v_cvt_pk_f16_f32 v13, v82, v83
  v_cvt_pk_f16_f32 v14, v84, v85
  v_cvt_pk_f16_f32 v15, v86, v87
  v_cvt_pk_f16_f32 v4, v88, v89
  v_cvt_pk_f16_f32 v5, v90, v91
  v_cvt_pk_f16_f32 v6, v92, v93
  v_cvt_pk_f16_f32 v7, v94, v95
  v_cvt_pk_f16_f32 v16, v96, v97
  v_cvt_pk_f16_f32 v17, v98, v99
  v_cvt_pk_f16_f32 v18, v100, v101
  v_cvt_pk_f16_f32 v19, v102, v103
  s_nop 7
  v_cvt_pk_f16_f32 v8, v120, v121
  v_cvt_pk_f16_f32 v9, v122, v123
  v_cvt_pk_f16_f32 v10, v124, v125
  v_cvt_pk_f16_f32 v11, v126, v127
  v_cvt_pk_f16_f32 v20, v128, v129
  v_cvt_pk_f16_f32 v21, v130, v131
  v_cvt_pk_f16_f32 v22, v132, v133
  v_cvt_pk_f16_f32 v23, v134, v135
  s_nop 0
  ds_write_b128 v114, v[0:3] offset:0
  ds_write_b128 v114, v[4:7] offset:1024
  ds_write_b128 v114, v[8:11] offset:2048
  ds_write_b128 v114, v[12:15] offset:3072
  ds_write_b128 v114, v[16:19] offset:4096
  ds_write_b128 v114, v[20:23] offset:5120
  s_waitcnt lgkmcnt(0)
  s_barrier
  s_waitcnt vmcnt(0)
  s_waitcnt lgkmcnt(0)
  ds_read_b128 v[136:139], v240 offset:0
  ds_read_b128 v[140:143], v240 offset:32
  ds_read_b128 v[144:147], v240 offset:64
  ds_read_b128 v[148:151], v240 offset:96
  v_mfma_f32_32x32x16_bf16 v[72:87], v[232:235], v[180:183], 0
  s_waitcnt lgkmcnt(3)
  v_mfma_f32_32x32x16_bf16 v[184:199], v[136:139], v[160:163], 0
  ds_read_b128 v[152:155], v240 offset:128
  s_waitcnt lgkmcnt(3)
  v_mfma_f32_32x32x16_bf16 v[184:199], v[140:143], v[164:167], v[184:199]
  ds_read_b128 v[156:159], v240 offset:160
  s_waitcnt lgkmcnt(3)
  v_mfma_f32_32x32x16_bf16 v[184:199], v[144:147], v[168:171], v[184:199]
  s_waitcnt lgkmcnt(2)
  v_mfma_f32_32x32x16_bf16 v[184:199], v[148:151], v[172:175], v[184:199]
  s_waitcnt lgkmcnt(1)
  v_mfma_f32_32x32x16_bf16 v[184:199], v[152:155], v[176:179], v[184:199]
  s_waitcnt lgkmcnt(0)
  v_mfma_f32_32x32x16_bf16 v[184:199], v[156:159], v[180:183], v[184:199]
  v_mfma_f32_32x32x16_bf16 v[88:103], v[200:203], v[160:163], v[72:87]
  v_mfma_f32_32x32x16_bf16 v[88:103], v[204:207], v[164:167], v[88:103]
  v_mfma_f32_32x32x16_bf16 v[120:135], v[208:211], v[168:171], v[72:87]
  v_mfma_f32_32x32x16_bf16 v[120:135], v[212:215], v[172:175], v[120:135]
  s_nop 7
  v_fmamk_f32 v243, v72, 0x42c00000, v184
  v_mfma_f32_32x32x16_bf16 v[184:199], v[216:219], v[176:179], v[72:87]
  v_mfma_f32_32x32x16_bf16 v[184:199], v[220:223], v[180:183], v[184:199]
  v_pk_mul_f32 v[244:245], v[88:89], v[88:89]
  v_pk_mul_f32 v[246:247], v[90:91], v[90:91]
  v_pk_fma_f32 v[244:245], v[92:93], v[92:93], v[244:245]
  v_pk_fma_f32 v[246:247], v[94:95], v[94:95], v[246:247]
  v_pk_fma_f32 v[244:245], v[96:97], v[96:97], v[244:245]
  v_pk_fma_f32 v[246:247], v[98:99], v[98:99], v[246:247]
  v_pk_fma_f32 v[244:245], v[100:101], v[100:101], v[244:245]
  v_pk_fma_f32 v[246:247], v[102:103], v[102:103], v[246:247]
  v_pk_fma_f32 v[244:245], v[120:121], v[120:121], v[244:245]
  v_pk_fma_f32 v[246:247], v[122:123], v[122:123], v[246:247]
  v_pk_fma_f32 v[244:245], v[124:125], v[124:125], v[244:245]
  v_pk_fma_f32 v[246:247], v[126:127], v[126:127], v[246:247]
  v_pk_fma_f32 v[244:245], v[128:129], v[128:129], v[244:245]
  v_pk_fma_f32 v[246:247], v[130:131], v[130:131], v[246:247]
  v_pk_fma_f32 v[244:245], v[132:133], v[132:133], v[244:245]
  v_pk_fma_f32 v[246:247], v[134:135], v[134:135], v[246:247]
  v_pk_fma_f32 v[244:245], v[184:185], v[184:185], v[244:245]
  v_pk_fma_f32 v[246:247], v[186:187], v[186:187], v[246:247]
  v_pk_fma_f32 v[244:245], v[188:189], v[188:189], v[244:245]
  v_pk_fma_f32 v[246:247], v[190:191], v[190:191], v[246:247]
  v_pk_fma_f32 v[244:245], v[192:193], v[192:193], v[244:245]
  v_pk_fma_f32 v[246:247], v[194:195], v[194:195], v[246:247]
  v_pk_fma_f32 v[244:245], v[196:197], v[196:197], v[244:245]
  v_pk_fma_f32 v[246:247], v[198:199], v[198:199], v[246:247]
  v_add_f32 v244, v244, v245
  v_add_f32 v246, v246, v247
  v_mul_f32 v249, v243, v243
  v_add_f32 v244, v244, v246
  v_mov_b32 v247, 0x383ee32f
  v_mov_b32 v245, v244
  s_nop 1
  v_permlane32_swap_b32 v244, v245
  v_add_f32 v244, v244, v245
  v_fma_f32 v244, v249, s43, v244
  v_fma_f32 v244, |v244|, s42, v247
  v_rsq_f32 v248, v244
  s_nop 0
  v_pk_mul_f32 v[88:89], v[88:89], v[248:249] op_sel_hi:[1,0]
  v_pk_mul_f32 v[90:91], v[90:91], v[248:249] op_sel_hi:[1,0]
  v_pk_mul_f32 v[92:93], v[92:93], v[248:249] op_sel_hi:[1,0]
  v_pk_mul_f32 v[94:95], v[94:95], v[248:249] op_sel_hi:[1,0]
  v_pk_mul_f32 v[96:97], v[96:97], v[248:249] op_sel_hi:[1,0]
  v_pk_mul_f32 v[98:99], v[98:99], v[248:249] op_sel_hi:[1,0]
  v_pk_mul_f32 v[100:101], v[100:101], v[248:249] op_sel_hi:[1,0]
  v_pk_mul_f32 v[102:103], v[102:103], v[248:249] op_sel_hi:[1,0]
  v_cvt_pk_bf16_f32 v48, v88, v89
  v_cvt_pk_bf16_f32 v49, v90, v91
  v_cvt_pk_bf16_f32 v50, v92, v93
  v_cvt_pk_bf16_f32 v51, v94, v95
  v_cvt_pk_bf16_f32 v52, v96, v97
  v_cvt_pk_bf16_f32 v53, v98, v99
  v_cvt_pk_bf16_f32 v54, v100, v101
  v_cvt_pk_bf16_f32 v55, v102, v103
  v_pk_mul_f32 v[120:121], v[120:121], v[248:249] op_sel_hi:[1,0]
  v_pk_mul_f32 v[122:123], v[122:123], v[248:249] op_sel_hi:[1,0]
  v_pk_mul_f32 v[124:125], v[124:125], v[248:249] op_sel_hi:[1,0]
  v_pk_mul_f32 v[126:127], v[126:127], v[248:249] op_sel_hi:[1,0]
  v_pk_mul_f32 v[128:129], v[128:129], v[248:249] op_sel_hi:[1,0]
  v_pk_mul_f32 v[130:131], v[130:131], v[248:249] op_sel_hi:[1,0]
  v_pk_mul_f32 v[132:133], v[132:133], v[248:249] op_sel_hi:[1,0]
  v_pk_mul_f32 v[134:135], v[134:135], v[248:249] op_sel_hi:[1,0]
  v_cvt_pk_bf16_f32 v56, v120, v121
  v_cvt_pk_bf16_f32 v57, v122, v123
  v_cvt_pk_bf16_f32 v58, v124, v125
  v_cvt_pk_bf16_f32 v59, v126, v127
  v_cvt_pk_bf16_f32 v60, v128, v129
  v_cvt_pk_bf16_f32 v61, v130, v131
  v_cvt_pk_bf16_f32 v62, v132, v133
  v_cvt_pk_bf16_f32 v63, v134, v135
  v_pk_mul_f32 v[184:185], v[184:185], v[248:249] op_sel_hi:[1,0]
  v_pk_mul_f32 v[186:187], v[186:187], v[248:249] op_sel_hi:[1,0]
  v_pk_mul_f32 v[188:189], v[188:189], v[248:249] op_sel_hi:[1,0]
  v_pk_mul_f32 v[190:191], v[190:191], v[248:249] op_sel_hi:[1,0]
  v_pk_mul_f32 v[192:193], v[192:193], v[248:249] op_sel_hi:[1,0]
  v_pk_mul_f32 v[194:195], v[194:195], v[248:249] op_sel_hi:[1,0]
  v_pk_mul_f32 v[196:197], v[196:197], v[248:249] op_sel_hi:[1,0]
  v_pk_mul_f32 v[198:199], v[198:199], v[248:249] op_sel_hi:[1,0]
  v_cvt_pk_bf16_f32 v64, v184, v185
  v_cvt_pk_bf16_f32 v65, v186, v187
  v_cvt_pk_bf16_f32 v66, v188, v189
  v_cvt_pk_bf16_f32 v67, v190, v191
  v_cvt_pk_bf16_f32 v68, v192, v193
  v_cvt_pk_bf16_f32 v69, v194, v195
  v_cvt_pk_bf16_f32 v70, v196, v197
  v_cvt_pk_bf16_f32 v71, v198, v199
  v_bfi_b32 v71, v242, s44, v71
  s_setprio 1
  s_mov_b32 s47, 0
L_pro_done:
  s_nop 0
  ds_read_b128 v[136:139], v236 offset:0
  ds_read_b128 v[140:143], v236 offset:1024
  ds_read_b128 v[144:147], v236 offset:2048
  ds_read_b128 v[148:151], v236 offset:3072
  s_waitcnt lgkmcnt(3)
  v_mfma_f32_32x32x16_bf16 v[72:87], v[136:139], v[48:51], 0
  ds_read_b128 v[152:155], v236 offset:4096
  s_waitcnt lgkmcnt(3)
  v_mfma_f32_32x32x16_bf16 v[72:87], v[140:143], v[52:55], v[72:87]
  ds_read_b128 v[156:159], v236 offset:5120
  s_waitcnt lgkmcnt(3)
  v_mfma_f32_32x32x16_bf16 v[72:87], v[144:147], v[56:59], v[72:87]
  ds_read_b128 v[136:139], v236 offset:6144
  s_waitcnt lgkmcnt(3)
  v_mfma_f32_32x32x16_bf16 v[72:87], v[148:151], v[60:63], v[72:87]
  ds_read_b128 v[140:143], v236 offset:7168
  s_waitcnt lgkmcnt(3)
  v_mfma_f32_32x32x16_bf16 v[72:87], v[152:155], v[64:67], v[72:87]
  ds_read_b128 v[144:147], v236 offset:8192
  s_waitcnt lgkmcnt(3)
  v_mfma_f32_32x32x16_bf16 v[72:87], v[156:159], v[68:71], v[72:87]
  ds_read_b128 v[148:151], v236 offset:9216
  ds_read_b128 v[0:3], v241 offset:0
  ds_read_b128 v[4:7], v241 offset:16
  ds_read_b128 v[8:11], v241 offset:32
  ds_read_b128 v[12:15], v241 offset:48
  ds_read_b128 v[16:19], v241 offset:128
  ds_read_b128 v[20:23], v241 offset:144
  ds_read_b128 v[24:27], v241 offset:160
  ds_read_b128 v[28:31], v241 offset:176
  ds_read_b128 v[32:35], v241 offset:256
  ds_read_b128 v[36:39], v241 offset:272
  ds_read_b128 v[40:43], v241 offset:288
  s_waitcnt lgkmcnt(13)
  ds_read_b128 v[44:47], v241 offset:304
L_loop:
  v_mfma_f32_32x32x16_bf16 v[88:103], v[136:139], v[48:51], 0
  ds_read_b128 v[152:155], v236 offset:10240
  v_cvt_pk_f16_f32 v120, v72, v73
  v_cvt_pk_f16_f32 v121, v74, v75
  v_cvt_pk_f16_f32 v122, v76, v77
  v_cvt_pk_f16_f32 v123, v78, v79
  v_cvt_pk_f16_f32 v124, v80, v81
  v_cvt_pk_f16_f32 v125, v82, v83
  v_cvt_pk_f16_f32 v126, v84, v85
  v_cvt_pk_f16_f32 v127, v86, v87
  v_pk_fma_f16 v128, v120, v120, s40
  s_waitcnt lgkmcnt(9)
  v_mfma_f32_32x32x16_bf16 v[0:15], v[224:227], v[160:163], v[0:15]
  v_pk_fma_f16 v129, v121, v121, s40
  v_pk_fma_f16 v130, v122, v122, s40
  v_pk_fma_f16 v131, v123, v123, s40
  v_pk_fma_f16 v132, v124, v124, s40
  v_pk_fma_f16 v133, v125, v125, s40
  v_pk_fma_f16 v134, v126, v126, s40
  v_pk_fma_f16 v135, v127, v127, s40
  v_pk_mul_f16 v128, v120, v128
  v_pk_mul_f16 v129, v121, v129
  v_mfma_f32_32x32x16_bf16 v[88:103], v[140:143], v[52:55], v[88:103]
  ds_read_b128 v[156:159], v236 offset:11264
  v_pk_mul_f16 v130, v122, v130
  v_pk_mul_f16 v131, v123, v131
  v_pk_mul_f16 v132, v124, v132
  v_pk_mul_f16 v133, v125, v133
  v_pk_mul_f16 v134, v126, v134
  v_pk_mul_f16 v135, v127, v135
  v_exp_f16_sdwa v128, -v128 dst_sel:WORD_0 dst_unused:UNUSED_PRESERVE src0_sel:WORD_0
  s_waitcnt lgkmcnt(6)
  v_mfma_f32_32x32x16_bf16 v[16:31], v[224:227], v[168:171], v[16:31]
  v_exp_f16_sdwa v129, -v129 dst_sel:WORD_0 dst_unused:UNUSED_PRESERVE src0_sel:WORD_0
  v_exp_f16_sdwa v130, -v130 dst_sel:WORD_0 dst_unused:UNUSED_PRESERVE src0_sel:WORD_0
  v_exp_f16_sdwa v131, -v131 dst_sel:WORD_0 dst_unused:UNUSED_PRESERVE src0_sel:WORD_0
  v_exp_f16_sdwa v132, -v132 dst_sel:WORD_0 dst_unused:UNUSED_PRESERVE src0_sel:WORD_0
  v_exp_f16_sdwa v133, -v133 dst_sel:WORD_0 dst_unused:UNUSED_PRESERVE src0_sel:WORD_0
  v_mfma_f32_32x32x16_bf16 v[88:103], v[144:147], v[56:59], v[88:103]
  ds_read_b128 v[136:139], v236 offset:12288
  v_exp_f16_sdwa v134, -v134 dst_sel:WORD_0 dst_unused:UNUSED_PRESERVE src0_sel:WORD_0
  v_exp_f16_sdwa v135, -v135 dst_sel:WORD_0 dst_unused:UNUSED_PRESERVE src0_sel:WORD_0
  v_exp_f16_sdwa v128, -v128 dst_sel:WORD_1 dst_unused:UNUSED_PRESERVE src0_sel:WORD_1
  v_exp_f16_sdwa v129, -v129 dst_sel:WORD_1 dst_unused:UNUSED_PRESERVE src0_sel:WORD_1
  s_waitcnt lgkmcnt(3)
  v_mfma_f32_32x32x16_bf16 v[32:47], v[224:227], v[176:179], v[32:47]
  v_exp_f16_sdwa v130, -v130 dst_sel:WORD_1 dst_unused:UNUSED_PRESERVE src0_sel:WORD_1
  v_exp_f16_sdwa v131, -v131 dst_sel:WORD_1 dst_unused:UNUSED_PRESERVE src0_sel:WORD_1
  v_exp_f16_sdwa v132, -v132 dst_sel:WORD_1 dst_unused:UNUSED_PRESERVE src0_sel:WORD_1
  v_exp_f16_sdwa v133, -v133 dst_sel:WORD_1 dst_unused:UNUSED_PRESERVE src0_sel:WORD_1
  v_mfma_f32_32x32x16_bf16 v[88:103], v[148:151], v[60:63], v[88:103]
  ds_read_b128 v[140:143], v237 offset:8192
  v_exp_f16_sdwa v134, -v134 dst_sel:WORD_1 dst_unused:UNUSED_PRESERVE src0_sel:WORD_1
  v_exp_f16_sdwa v135, -v135 dst_sel:WORD_1 dst_unused:UNUSED_PRESERVE src0_sel:WORD_1
  v_pk_fma_f16 v128, v128, s41, s41
  v_pk_fma_f16 v129, v129, s41, s41
  v_pk_fma_f16 v130, v130, s41, s41
  v_pk_fma_f16 v131, v131, s41, s41
  v_pk_fma_f16 v132, v132, s41, s41
  v_mfma_f32_32x32x16_bf16 v[0:15], v[228:231], v[164:167], v[0:15]
  v_pk_fma_f16 v133, v133, s41, s41
  v_pk_fma_f16 v134, v134, s41, s41
  v_pk_fma_f16 v135, v135, s41, s41
  v_rcp_f16_sdwa v128, v128 dst_sel:WORD_0 dst_unused:UNUSED_PRESERVE src0_sel:WORD_0
  v_rcp_f16_sdwa v129, v129 dst_sel:WORD_0 dst_unused:UNUSED_PRESERVE src0_sel:WORD_0
  v_rcp_f16_sdwa v130, v130 dst_sel:WORD_0 dst_unused:UNUSED_PRESERVE src0_sel:WORD_0
  s_waitcnt lgkmcnt(3)
  v_mfma_f32_32x32x16_bf16 v[88:103], v[152:155], v[64:67], v[88:103]
  ds_read_b128 v[144:147], v236 offset:13312
  v_rcp_f16_sdwa v131, v131 dst_sel:WORD_0 dst_unused:UNUSED_PRESERVE src0_sel:WORD_0
  v_rcp_f16_sdwa v132, v132 dst_sel:WORD_0 dst_unused:UNUSED_PRESERVE src0_sel:WORD_0
  v_rcp_f16_sdwa v133, v133 dst_sel:WORD_0 dst_unused:UNUSED_PRESERVE src0_sel:WORD_0
  v_rcp_f16_sdwa v134, v134 dst_sel:WORD_0 dst_unused:UNUSED_PRESERVE src0_sel:WORD_0
  v_mfma_f32_32x32x16_bf16 v[16:31], v[228:231], v[172:175], v[16:31]
  v_rcp_f16_sdwa v135, v135 dst_sel:WORD_0 dst_unused:UNUSED_PRESERVE src0_sel:WORD_0
  v_rcp_f16_sdwa v128, v128 dst_sel:WORD_1 dst_unused:UNUSED_PRESERVE src0_sel:WORD_1
  v_rcp_f16_sdwa v129, v129 dst_sel:WORD_1 dst_unused:UNUSED_PRESERVE src0_sel:WORD_1
  v_rcp_f16_sdwa v130, v130 dst_sel:WORD_1 dst_unused:UNUSED_PRESERVE src0_sel:WORD_1
  v_rcp_f16_sdwa v131, v131 dst_sel:WORD_1 dst_unused:UNUSED_PRESERVE src0_sel:WORD_1
  s_waitcnt lgkmcnt(3)
  v_mfma_f32_32x32x16_bf16 v[88:103], v[156:159], v[68:71], v[88:103]
  ds_read_b128 v[148:151], v237 offset:9216
  v_rcp_f16_sdwa v132, v132 dst_sel:WORD_1 dst_unused:UNUSED_PRESERVE src0_sel:WORD_1
  v_rcp_f16_sdwa v133, v133 dst_sel:WORD_1 dst_unused:UNUSED_PRESERVE src0_sel:WORD_1
  v_rcp_f16_sdwa v134, v134 dst_sel:WORD_1 dst_unused:UNUSED_PRESERVE src0_sel:WORD_1
  v_rcp_f16_sdwa v135, v135 dst_sel:WORD_1 dst_unused:UNUSED_PRESERVE src0_sel:WORD_1
  v_mfma_f32_32x32x16_bf16 v[32:47], v[228:231], v[180:183], v[32:47]
  v_add_u32 v250, s38, v239
  buffer_load_dwordx4 v[160:163], v250, s[20:23], 0 offen offset:0
  buffer_load_dwordx4 v[164:167], v250, s[20:23], 0 offen offset:32
  buffer_load_dwordx4 v[168:171], v250, s[20:23], 0 offen offset:64
  buffer_load_dwordx4 v[172:175], v250, s[20:23], 0 offen offset:96
  buffer_load_dwordx4 v[176:179], v250, s[20:23], 0 offen offset:128
  buffer_load_dwordx4 v[180:183], v250, s[20:23], 0 offen offset:160
  v_pk_mul_f16 v104, v120, v128
  v_pk_mul_f16 v105, v121, v129
  v_pk_mul_f16 v106, v122, v130
  v_pk_mul_f16 v107, v123, v131
  v_pk_mul_f16 v108, v124, v132
  v_pk_mul_f16 v109, v125, v133
  v_pk_mul_f16 v110, v126, v134
  v_pk_mul_f16 v111, v127, v135
  s_waitcnt lgkmcnt(3)
  v_mfma_f32_32x32x16_bf16 v[72:87], v[136:139], v[48:51], 0
  ds_read_b128 v[152:155], v236 offset:14336
  v_cvt_pk_f16_f32 v120, v88, v89
  v_cvt_pk_f16_f32 v121, v90, v91
  v_cvt_pk_f16_f32 v122, v92, v93
  v_cvt_pk_f16_f32 v123, v94, v95
  v_cvt_pk_f16_f32 v124, v96, v97
  v_cvt_pk_f16_f32 v125, v98, v99
  v_cvt_pk_f16_f32 v126, v100, v101
  v_cvt_pk_f16_f32 v127, v102, v103
  v_pk_fma_f16 v128, v120, v120, s40
  s_waitcnt lgkmcnt(3)
  v_mfma_f32_32x32x16_f16 v[0:15], v[140:143], v[104:107], v[0:15]
  ds_read_b128 v[156:159], v237 offset:10240
  v_pk_fma_f16 v129, v121, v121, s40
  v_pk_fma_f16 v130, v122, v122, s40
  v_pk_fma_f16 v131, v123, v123, s40
  v_pk_fma_f16 v132, v124, v124, s40
  v_pk_fma_f16 v133, v125, v125, s40
  v_pk_fma_f16 v134, v126, v126, s40
  v_pk_fma_f16 v135, v127, v127, s40
  v_pk_mul_f16 v128, v120, v128
  v_pk_mul_f16 v129, v121, v129
  s_waitcnt lgkmcnt(3)
  v_mfma_f32_32x32x16_bf16 v[72:87], v[144:147], v[52:55], v[72:87]
  ds_read_b128 v[136:139], v236 offset:15360
  v_pk_mul_f16 v130, v122, v130
  v_pk_mul_f16 v131, v123, v131
  v_pk_mul_f16 v132, v124, v132
  v_pk_mul_f16 v133, v125, v133
  v_pk_mul_f16 v134, v126, v134
  v_pk_mul_f16 v135, v127, v135
  v_exp_f16_sdwa v128, -v128 dst_sel:WORD_0 dst_unused:UNUSED_PRESERVE src0_sel:WORD_0
  s_waitcnt lgkmcnt(3)
  v_mfma_f32_32x32x16_f16 v[16:31], v[148:151], v[104:107], v[16:31]
  ds_read_b128 v[140:143], v237 offset:11264
  v_exp_f16_sdwa v129, -v129 dst_sel:WORD_0 dst_unused:UNUSED_PRESERVE src0_sel:WORD_0
  v_exp_f16_sdwa v130, -v130 dst_sel:WORD_0 dst_unused:UNUSED_PRESERVE src0_sel:WORD_0
  v_exp_f16_sdwa v131, -v131 dst_sel:WORD_0 dst_unused:UNUSED_PRESERVE src0_sel:WORD_0
  v_exp_f16_sdwa v132, -v132 dst_sel:WORD_0 dst_unused:UNUSED_PRESERVE src0_sel:WORD_0
  v_exp_f16_sdwa v133, -v133 dst_sel:WORD_0 dst_unused:UNUSED_PRESERVE src0_sel:WORD_0
  s_waitcnt lgkmcnt(3)
  v_mfma_f32_32x32x16_bf16 v[72:87], v[152:155], v[56:59], v[72:87]
  ds_read_b128 v[144:147], v236 offset:16384
  v_exp_f16_sdwa v134, -v134 dst_sel:WORD_0 dst_unused:UNUSED_PRESERVE src0_sel:WORD_0
  v_exp_f16_sdwa v135, -v135 dst_sel:WORD_0 dst_unused:UNUSED_PRESERVE src0_sel:WORD_0
  v_exp_f16_sdwa v128, -v128 dst_sel:WORD_1 dst_unused:UNUSED_PRESERVE src0_sel:WORD_1
  v_exp_f16_sdwa v129, -v129 dst_sel:WORD_1 dst_unused:UNUSED_PRESERVE src0_sel:WORD_1
  s_waitcnt lgkmcnt(3)
  v_mfma_f32_32x32x16_f16 v[32:47], v[156:159], v[104:107], v[32:47]
  ds_read_b128 v[148:151], v237 offset:12288
  v_exp_f16_sdwa v130, -v130 dst_sel:WORD_1 dst_unused:UNUSED_PRESERVE src0_sel:WORD_1
  v_exp_f16_sdwa v131, -v131 dst_sel:WORD_1 dst_unused:UNUSED_PRESERVE src0_sel:WORD_1
  v_exp_f16_sdwa v132, -v132 dst_sel:WORD_1 dst_unused:UNUSED_PRESERVE src0_sel:WORD_1
  v_exp_f16_sdwa v133, -v133 dst_sel:WORD_1 dst_unused:UNUSED_PRESERVE src0_sel:WORD_1
  s_waitcnt lgkmcnt(3)
  v_mfma_f32_32x32x16_bf16 v[72:87], v[136:139], v[60:63], v[72:87]
  ds_read_b128 v[152:155], v236 offset:17408
  v_exp_f16_sdwa v134, -v134 dst_sel:WORD_1 dst_unused:UNUSED_PRESERVE src0_sel:WORD_1
  v_exp_f16_sdwa v135, -v135 dst_sel:WORD_1 dst_unused:UNUSED_PRESERVE src0_sel:WORD_1
  v_pk_fma_f16 v128, v128, s41, s41
  v_pk_fma_f16 v129, v129, s41, s41
  v_pk_fma_f16 v130, v130, s41, s41
  v_pk_fma_f16 v131, v131, s41, s41
  v_pk_fma_f16 v132, v132, s41, s41
  s_waitcnt lgkmcnt(3)
  v_mfma_f32_32x32x16_f16 v[0:15], v[140:143], v[108:111], v[0:15]
  ds_read_b128 v[156:159], v237 offset:13312
  v_pk_fma_f16 v133, v133, s41, s41
  v_pk_fma_f16 v134, v134, s41, s41
  v_pk_fma_f16 v135, v135, s41, s41
  v_rcp_f16_sdwa v128, v128 dst_sel:WORD_0 dst_unused:UNUSED_PRESERVE src0_sel:WORD_0
  v_rcp_f16_sdwa v129, v129 dst_sel:WORD_0 dst_unused:UNUSED_PRESERVE src0_sel:WORD_0
  v_rcp_f16_sdwa v130, v130 dst_sel:WORD_0 dst_unused:UNUSED_PRESERVE src0_sel:WORD_0
  s_waitcnt lgkmcnt(3)
  v_mfma_f32_32x32x16_bf16 v[72:87], v[144:147], v[64:67], v[72:87]
  ds_read_b128 v[136:139], v236 offset:18432
  v_rcp_f16_sdwa v131, v131 dst_sel:WORD_0 dst_unused:UNUSED_PRESERVE src0_sel:WORD_0
  v_rcp_f16_sdwa v132, v132 dst_sel:WORD_0 dst_unused:UNUSED_PRESERVE src0_sel:WORD_0
  v_rcp_f16_sdwa v133, v133 dst_sel:WORD_0 dst_unused:UNUSED_PRESERVE src0_sel:WORD_0
  v_rcp_f16_sdwa v134, v134 dst_sel:WORD_0 dst_unused:UNUSED_PRESERVE src0_sel:WORD_0
  s_waitcnt lgkmcnt(3)
  v_mfma_f32_32x32x16_f16 v[16:31], v[148:151], v[108:111], v[16:31]
  ds_read_b128 v[140:143], v237 offset:14336
  v_rcp_f16_sdwa v135, v135 dst_sel:WORD_0 dst_unused:UNUSED_PRESERVE src0_sel:WORD_0
  v_rcp_f16_sdwa v128, v128 dst_sel:WORD_1 dst_unused:UNUSED_PRESERVE src0_sel:WORD_1
  v_rcp_f16_sdwa v129, v129 dst_sel:WORD_1 dst_unused:UNUSED_PRESERVE src0_sel:WORD_1
  v_rcp_f16_sdwa v130, v130 dst_sel:WORD_1 dst_unused:UNUSED_PRESERVE src0_sel:WORD_1
  v_rcp_f16_sdwa v131, v131 dst_sel:WORD_1 dst_unused:UNUSED_PRESERVE src0_sel:WORD_1
  s_waitcnt lgkmcnt(3)
  v_mfma_f32_32x32x16_bf16 v[72:87], v[152:155], v[68:71], v[72:87]
  ds_read_b128 v[144:147], v236 offset:19456
  v_rcp_f16_sdwa v132, v132 dst_sel:WORD_1 dst_unused:UNUSED_PRESERVE src0_sel:WORD_1
  v_rcp_f16_sdwa v133, v133 dst_sel:WORD_1 dst_unused:UNUSED_PRESERVE src0_sel:WORD_1
  v_rcp_f16_sdwa v134, v134 dst_sel:WORD_1 dst_unused:UNUSED_PRESERVE src0_sel:WORD_1
  v_rcp_f16_sdwa v135, v135 dst_sel:WORD_1 dst_unused:UNUSED_PRESERVE src0_sel:WORD_1
  s_waitcnt lgkmcnt(3)
  v_mfma_f32_32x32x16_f16 v[32:47], v[156:159], v[108:111], v[32:47]
  ds_read_b128 v[148:151], v237 offset:15360
  v_pk_mul_f16 v112, v120, v128
  v_pk_mul_f16 v113, v121, v129
  v_pk_mul_f16 v114, v122, v130
  v_pk_mul_f16 v115, v123, v131
  v_pk_mul_f16 v116, v124, v132
  v_pk_mul_f16 v117, v125, v133
  v_pk_mul_f16 v118, v126, v134
  v_pk_mul_f16 v119, v127, v135
  s_waitcnt lgkmcnt(3)
  v_mfma_f32_32x32x16_bf16 v[88:103], v[136:139], v[48:51], 0
  ds_read_b128 v[152:155], v236 offset:20480
  v_cvt_pk_f16_f32 v120, v72, v73
  v_cvt_pk_f16_f32 v121, v74, v75
  v_cvt_pk_f16_f32 v122, v76, v77
  v_cvt_pk_f16_f32 v123, v78, v79
  v_cvt_pk_f16_f32 v124, v80, v81
  v_cvt_pk_f16_f32 v125, v82, v83
  v_cvt_pk_f16_f32 v126, v84, v85
  v_cvt_pk_f16_f32 v127, v86, v87
  v_pk_fma_f16 v128, v120, v120, s40
  s_waitcnt lgkmcnt(3)
  v_mfma_f32_32x32x16_f16 v[0:15], v[140:143], v[112:115], v[0:15]
  ds_read_b128 v[156:159], v237 offset:16384
  v_pk_fma_f16 v129, v121, v121, s40
  v_pk_fma_f16 v130, v122, v122, s40
  v_pk_fma_f16 v131, v123, v123, s40
  v_pk_fma_f16 v132, v124, v124, s40
  v_pk_fma_f16 v133, v125, v125, s40
  v_pk_fma_f16 v134, v126, v126, s40
  v_pk_fma_f16 v135, v127, v127, s40
  v_pk_mul_f16 v128, v120, v128
  v_pk_mul_f16 v129, v121, v129
  s_waitcnt lgkmcnt(3)
  v_mfma_f32_32x32x16_bf16 v[88:103], v[144:147], v[52:55], v[88:103]
  ds_read_b128 v[136:139], v236 offset:21504
  v_pk_mul_f16 v130, v122, v130
  v_pk_mul_f16 v131, v123, v131
  v_pk_mul_f16 v132, v124, v132
  v_pk_mul_f16 v133, v125, v133
  v_pk_mul_f16 v134, v126, v134
  v_pk_mul_f16 v135, v127, v135
  v_exp_f16_sdwa v128, -v128 dst_sel:WORD_0 dst_unused:UNUSED_PRESERVE src0_sel:WORD_0
  s_waitcnt lgkmcnt(3)
  v_mfma_f32_32x32x16_f16 v[16:31], v[148:151], v[112:115], v[16:31]
  ds_read_b128 v[140:143], v237 offset:17408
  v_exp_f16_sdwa v129, -v129 dst_sel:WORD_0 dst_unused:UNUSED_PRESERVE src0_sel:WORD_0
  v_exp_f16_sdwa v130, -v130 dst_sel:WORD_0 dst_unused:UNUSED_PRESERVE src0_sel:WORD_0
  v_exp_f16_sdwa v131, -v131 dst_sel:WORD_0 dst_unused:UNUSED_PRESERVE src0_sel:WORD_0
  v_exp_f16_sdwa v132, -v132 dst_sel:WORD_0 dst_unused:UNUSED_PRESERVE src0_sel:WORD_0
  v_exp_f16_sdwa v133, -v133 dst_sel:WORD_0 dst_unused:UNUSED_PRESERVE src0_sel:WORD_0
  s_waitcnt lgkmcnt(3)
  v_mfma_f32_32x32x16_bf16 v[88:103], v[152:155], v[56:59], v[88:103]
  ds_read_b128 v[144:147], v236 offset:22528
  v_exp_f16_sdwa v134, -v134 dst_sel:WORD_0 dst_unused:UNUSED_PRESERVE src0_sel:WORD_0
  v_exp_f16_sdwa v135, -v135 dst_sel:WORD_0 dst_unused:UNUSED_PRESERVE src0_sel:WORD_0
  v_exp_f16_sdwa v128, -v128 dst_sel:WORD_1 dst_unused:UNUSED_PRESERVE src0_sel:WORD_1
  v_exp_f16_sdwa v129, -v129 dst_sel:WORD_1 dst_unused:UNUSED_PRESERVE src0_sel:WORD_1
  s_waitcnt lgkmcnt(3)
  v_mfma_f32_32x32x16_f16 v[32:47], v[156:159], v[112:115], v[32:47]
  ds_read_b128 v[148:151], v237 offset:18432
  v_exp_f16_sdwa v130, -v130 dst_sel:WORD_1 dst_unused:UNUSED_PRESERVE src0_sel:WORD_1
  v_exp_f16_sdwa v131, -v131 dst_sel:WORD_1 dst_unused:UNUSED_PRESERVE src0_sel:WORD_1
  v_exp_f16_sdwa v132, -v132 dst_sel:WORD_1 dst_unused:UNUSED_PRESERVE src0_sel:WORD_1
  v_exp_f16_sdwa v133, -v133 dst_sel:WORD_1 dst_unused:UNUSED_PRESERVE src0_sel:WORD_1
  s_waitcnt lgkmcnt(3)
  v_mfma_f32_32x32x16_bf16 v[88:103], v[136:139], v[60:63], v[88:103]
  ds_read_b128 v[152:155], v236 offset:23552
  v_exp_f16_sdwa v134, -v134 dst_sel:WORD_1 dst_unused:UNUSED_PRESERVE src0_sel:WORD_1
  v_exp_f16_sdwa v135, -v135 dst_sel:WORD_1 dst_unused:UNUSED_PRESERVE src0_sel:WORD_1
  v_pk_fma_f16 v128, v128, s41, s41
  v_pk_fma_f16 v129, v129, s41, s41
  v_pk_fma_f16 v130, v130, s41, s41
  v_pk_fma_f16 v131, v131, s41, s41
  v_pk_fma_f16 v132, v132, s41, s41
  s_waitcnt lgkmcnt(3)
  v_mfma_f32_32x32x16_f16 v[0:15], v[140:143], v[116:119], v[0:15]
  ds_read_b128 v[156:159], v237 offset:19456
  v_pk_fma_f16 v133, v133, s41, s41
  v_pk_fma_f16 v134, v134, s41, s41
  v_pk_fma_f16 v135, v135, s41, s41
  v_rcp_f16_sdwa v128, v128 dst_sel:WORD_0 dst_unused:UNUSED_PRESERVE src0_sel:WORD_0
  v_rcp_f16_sdwa v129, v129 dst_sel:WORD_0 dst_unused:UNUSED_PRESERVE src0_sel:WORD_0
  v_rcp_f16_sdwa v130, v130 dst_sel:WORD_0 dst_unused:UNUSED_PRESERVE src0_sel:WORD_0
  s_waitcnt lgkmcnt(3)
  v_mfma_f32_32x32x16_bf16 v[88:103], v[144:147], v[64:67], v[88:103]
  s_cmp_lg_u32 s47, 2
  s_cbranch_scc1 L_nob0
  s_barrier
  s_mov_b32 s47, 1
L_nob0:
  ds_read_b128 v[136:139], v236 offset:24576
  v_rcp_f16_sdwa v131, v131 dst_sel:WORD_0 dst_unused:UNUSED_PRESERVE src0_sel:WORD_0
  v_rcp_f16_sdwa v132, v132 dst_sel:WORD_0 dst_unused:UNUSED_PRESERVE src0_sel:WORD_0
  v_rcp_f16_sdwa v133, v133 dst_sel:WORD_0 dst_unused:UNUSED_PRESERVE src0_sel:WORD_0
  v_rcp_f16_sdwa v134, v134 dst_sel:WORD_0 dst_unused:UNUSED_PRESERVE src0_sel:WORD_0
  s_waitcnt lgkmcnt(3)
  v_mfma_f32_32x32x16_f16 v[16:31], v[148:151], v[116:119], v[16:31]
  ds_read_b128 v[140:143], v237 offset:20480
  v_rcp_f16_sdwa v135, v135 dst_sel:WORD_0 dst_unused:UNUSED_PRESERVE src0_sel:WORD_0
  v_rcp_f16_sdwa v128, v128 dst_sel:WORD_1 dst_unused:UNUSED_PRESERVE src0_sel:WORD_1
  v_rcp_f16_sdwa v129, v129 dst_sel:WORD_1 dst_unused:UNUSED_PRESERVE src0_sel:WORD_1
  v_rcp_f16_sdwa v130, v130 dst_sel:WORD_1 dst_unused:UNUSED_PRESERVE src0_sel:WORD_1
  v_rcp_f16_sdwa v131, v131 dst_sel:WORD_1 dst_unused:UNUSED_PRESERVE src0_sel:WORD_1
  s_waitcnt lgkmcnt(3)
  v_mfma_f32_32x32x16_bf16 v[88:103], v[152:155], v[68:71], v[88:103]
  ds_read_b128 v[144:147], v236 offset:25600
  v_rcp_f16_sdwa v132, v132 dst_sel:WORD_1 dst_unused:UNUSED_PRESERVE src0_sel:WORD_1
  v_rcp_f16_sdwa v133, v133 dst_sel:WORD_1 dst_unused:UNUSED_PRESERVE src0_sel:WORD_1
  v_rcp_f16_sdwa v134, v134 dst_sel:WORD_1 dst_unused:UNUSED_PRESERVE src0_sel:WORD_1
  v_rcp_f16_sdwa v135, v135 dst_sel:WORD_1 dst_unused:UNUSED_PRESERVE src0_sel:WORD_1
  s_waitcnt lgkmcnt(3)
  v_mfma_f32_32x32x16_f16 v[32:47], v[156:159], v[116:119], v[32:47]
  ds_read_b128 v[148:151], v237 offset:21504
  v_pk_mul_f16 v104, v120, v128
  v_pk_mul_f16 v105, v121, v129
  v_pk_mul_f16 v106, v122, v130
  v_pk_mul_f16 v107, v123, v131
  v_pk_mul_f16 v108, v124, v132
  v_pk_mul_f16 v109, v125, v133
  v_pk_mul_f16 v110, v126, v134
  v_pk_mul_f16 v111, v127, v135
  s_waitcnt lgkmcnt(3)
  v_mfma_f32_32x32x16_bf16 v[72:87], v[136:139], v[48:51], 0
  ds_read_b128 v[152:155], v236 offset:26624
  v_cvt_pk_f16_f32 v120, v88, v89
  v_cvt_pk_f16_f32 v121, v90, v91
  v_cvt_pk_f16_f32 v122, v92, v93
  v_cvt_pk_f16_f32 v123, v94, v95
  v_cvt_pk_f16_f32 v124, v96, v97
  v_cvt_pk_f16_f32 v125, v98, v99
  v_cvt_pk_f16_f32 v126, v100, v101
  v_cvt_pk_f16_f32 v127, v102, v103
  v_pk_fma_f16 v128, v120, v120, s40
  s_waitcnt lgkmcnt(3)
  v_mfma_f32_32x32x16_f16 v[0:15], v[140:143], v[104:107], v[0:15]
  ds_read_b128 v[156:159], v237 offset:22528
  v_pk_fma_f16 v129, v121, v121, s40
  v_pk_fma_f16 v130, v122, v122, s40
  v_pk_fma_f16 v131, v123, v123, s40
  v_pk_fma_f16 v132, v124, v124, s40
  v_pk_fma_f16 v133, v125, v125, s40
  v_pk_fma_f16 v134, v126, v126, s40
  v_pk_fma_f16 v135, v127, v127, s40
  v_pk_mul_f16 v128, v120, v128
  v_pk_mul_f16 v129, v121, v129
  s_waitcnt lgkmcnt(3)
  v_mfma_f32_32x32x16_bf16 v[72:87], v[144:147], v[52:55], v[72:87]
  ds_read_b128 v[136:139], v236 offset:27648
  v_pk_mul_f16 v130, v122, v130
  v_pk_mul_f16 v131, v123, v131
  s_cmp_lg_u32 s39, 3
  s_cbranch_scc1 L_nosw
  s_cmp_ge_u32 s36, 4
  s_cbranch_scc1 L_nosw
  s_setprio 0
L_nosw:
  v_pk_mul_f16 v132, v124, v132
  v_pk_mul_f16 v133, v125, v133
  v_pk_mul_f16 v134, v126, v134
  v_pk_mul_f16 v135, v127, v135
  v_exp_f16_sdwa v128, -v128 dst_sel:WORD_0 dst_unused:UNUSED_PRESERVE src0_sel:WORD_0
  s_waitcnt lgkmcnt(3)
  v_mfma_f32_32x32x16_f16 v[16:31], v[148:151], v[104:107], v[16:31]
  ds_read_b128 v[140:143], v237 offset:23552
  v_exp_f16_sdwa v129, -v129 dst_sel:WORD_0 dst_unused:UNUSED_PRESERVE src0_sel:WORD_0
  v_exp_f16_sdwa v130, -v130 dst_sel:WORD_0 dst_unused:UNUSED_PRESERVE src0_sel:WORD_0
  v_exp_f16_sdwa v131, -v131 dst_sel:WORD_0 dst_unused:UNUSED_PRESERVE src0_sel:WORD_0
  v_exp_f16_sdwa v132, -v132 dst_sel:WORD_0 dst_unused:UNUSED_PRESERVE src0_sel:WORD_0
  v_exp_f16_sdwa v133, -v133 dst_sel:WORD_0 dst_unused:UNUSED_PRESERVE src0_sel:WORD_0
  s_waitcnt lgkmcnt(3)
  v_mfma_f32_32x32x16_bf16 v[72:87], v[152:155], v[56:59], v[72:87]
  ds_read_b128 v[144:147], v236 offset:28672
  v_exp_f16_sdwa v134, -v134 dst_sel:WORD_0 dst_unused:UNUSED_PRESERVE src0_sel:WORD_0
  v_exp_f16_sdwa v135, -v135 dst_sel:WORD_0 dst_unused:UNUSED_PRESERVE src0_sel:WORD_0
  v_exp_f16_sdwa v128, -v128 dst_sel:WORD_1 dst_unused:UNUSED_PRESERVE src0_sel:WORD_1
  v_exp_f16_sdwa v129, -v129 dst_sel:WORD_1 dst_unused:UNUSED_PRESERVE src0_sel:WORD_1
  s_waitcnt lgkmcnt(3)
  v_mfma_f32_32x32x16_f16 v[32:47], v[156:159], v[104:107], v[32:47]
  ds_read_b128 v[148:151], v237 offset:24576
  v_exp_f16_sdwa v130, -v130 dst_sel:WORD_1 dst_unused:UNUSED_PRESERVE src0_sel:WORD_1
  v_exp_f16_sdwa v131, -v131 dst_sel:WORD_1 dst_unused:UNUSED_PRESERVE src0_sel:WORD_1
  v_exp_f16_sdwa v132, -v132 dst_sel:WORD_1 dst_unused:UNUSED_PRESERVE src0_sel:WORD_1
  v_exp_f16_sdwa v133, -v133 dst_sel:WORD_1 dst_unused:UNUSED_PRESERVE src0_sel:WORD_1
  s_waitcnt lgkmcnt(3)
  v_mfma_f32_32x32x16_bf16 v[72:87], v[136:139], v[60:63], v[72:87]
  ds_read_b128 v[152:155], v236 offset:29696
  v_exp_f16_sdwa v134, -v134 dst_sel:WORD_1 dst_unused:UNUSED_PRESERVE src0_sel:WORD_1
  v_exp_f16_sdwa v135, -v135 dst_sel:WORD_1 dst_unused:UNUSED_PRESERVE src0_sel:WORD_1
  v_pk_fma_f16 v128, v128, s41, s41
  v_pk_fma_f16 v129, v129, s41, s41
  v_pk_fma_f16 v130, v130, s41, s41
  v_pk_fma_f16 v131, v131, s41, s41
  v_pk_fma_f16 v132, v132, s41, s41
  s_waitcnt lgkmcnt(3)
  v_mfma_f32_32x32x16_f16 v[0:15], v[140:143], v[108:111], v[0:15]
  ds_read_b128 v[156:159], v237 offset:25600
  v_pk_fma_f16 v133, v133, s41, s41
  v_pk_fma_f16 v134, v134, s41, s41
  v_pk_fma_f16 v135, v135, s41, s41
  v_rcp_f16_sdwa v128, v128 dst_sel:WORD_0 dst_unused:UNUSED_PRESERVE src0_sel:WORD_0
  v_rcp_f16_sdwa v129, v129 dst_sel:WORD_0 dst_unused:UNUSED_PRESERVE src0_sel:WORD_0
  v_rcp_f16_sdwa v130, v130 dst_sel:WORD_0 dst_unused:UNUSED_PRESERVE src0_sel:WORD_0
  s_waitcnt lgkmcnt(3)
  v_mfma_f32_32x32x16_bf16 v[72:87], v[144:147], v[64:67], v[72:87]
  ds_read_b128 v[136:139], v236 offset:30720
  v_rcp_f16_sdwa v131, v131 dst_sel:WORD_0 dst_unused:UNUSED_PRESERVE src0_sel:WORD_0
  v_rcp_f16_sdwa v132, v132 dst_sel:WORD_0 dst_unused:UNUSED_PRESERVE src0_sel:WORD_0
  v_rcp_f16_sdwa v133, v133 dst_sel:WORD_0 dst_unused:UNUSED_PRESERVE src0_sel:WORD_0
  v_rcp_f16_sdwa v134, v134 dst_sel:WORD_0 dst_unused:UNUSED_PRESERVE src0_sel:WORD_0
  s_waitcnt lgkmcnt(3)
  v_mfma_f32_32x32x16_f16 v[16:31], v[148:151], v[108:111], v[16:31]
  ds_read_b128 v[140:143], v237 offset:26624
  v_rcp_f16_sdwa v135, v135 dst_sel:WORD_0 dst_unused:UNUSED_PRESERVE src0_sel:WORD_0
  v_rcp_f16_sdwa v128, v128 dst_sel:WORD_1 dst_unused:UNUSED_PRESERVE src0_sel:WORD_1
  v_rcp_f16_sdwa v129, v129 dst_sel:WORD_1 dst_unused:UNUSED_PRESERVE src0_sel:WORD_1
  v_rcp_f16_sdwa v130, v130 dst_sel:WORD_1 dst_unused:UNUSED_PRESERVE src0_sel:WORD_1
  v_rcp_f16_sdwa v131, v131 dst_sel:WORD_1 dst_unused:UNUSED_PRESERVE src0_sel:WORD_1
  s_waitcnt lgkmcnt(3)
  v_mfma_f32_32x32x16_bf16 v[72:87], v[152:155], v[68:71], v[72:87]
  ds_read_b128 v[144:147], v236 offset:31744
  v_rcp_f16_sdwa v132, v132 dst_sel:WORD_1 dst_unused:UNUSED_PRESERVE src0_sel:WORD_1
  v_rcp_f16_sdwa v133, v133 dst_sel:WORD_1 dst_unused:UNUSED_PRESERVE src0_sel:WORD_1
  v_rcp_f16_sdwa v134, v134 dst_sel:WORD_1 dst_unused:UNUSED_PRESERVE src0_sel:WORD_1
  v_rcp_f16_sdwa v135, v135 dst_sel:WORD_1 dst_unused:UNUSED_PRESERVE src0_sel:WORD_1
  s_waitcnt lgkmcnt(3)
  v_mfma_f32_32x32x16_f16 v[32:47], v[156:159], v[108:111], v[32:47]
  ds_read_b128 v[148:151], v237 offset:27648
  v_pk_mul_f16 v112, v120, v128
  v_pk_mul_f16 v113, v121, v129
  v_pk_mul_f16 v114, v122, v130
  v_pk_mul_f16 v115, v123, v131
  v_pk_mul_f16 v116, v124, v132
  v_pk_mul_f16 v117, v125, v133
  v_pk_mul_f16 v118, v126, v134
  v_pk_mul_f16 v119, v127, v135
  s_waitcnt lgkmcnt(3)
  v_mfma_f32_32x32x16_bf16 v[88:103], v[136:139], v[48:51], 0
  ds_read_b128 v[152:155], v236 offset:32768
  v_cvt_pk_f16_f32 v120, v72, v73
  v_cvt_pk_f16_f32 v121, v74, v75
  v_cvt_pk_f16_f32 v122, v76, v77
  v_cvt_pk_f16_f32 v123, v78, v79
  v_cvt_pk_f16_f32 v124, v80, v81
  v_cvt_pk_f16_f32 v125, v82, v83
  v_cvt_pk_f16_f32 v126, v84, v85
  v_cvt_pk_f16_f32 v127, v86, v87
  v_pk_fma_f16 v128, v120, v120, s40
  s_waitcnt lgkmcnt(3)
  v_mfma_f32_32x32x16_f16 v[0:15], v[140:143], v[112:115], v[0:15]
  ds_read_b128 v[156:159], v237 offset:28672
  v_pk_fma_f16 v129, v121, v121, s40
  v_pk_fma_f16 v130, v122, v122, s40
  v_pk_fma_f16 v131, v123, v123, s40
  v_pk_fma_f16 v132, v124, v124, s40
  v_pk_fma_f16 v133, v125, v125, s40
  v_pk_fma_f16 v134, v126, v126, s40
  v_pk_fma_f16 v135, v127, v127, s40
  v_pk_mul_f16 v128, v120, v128
  v_pk_mul_f16 v129, v121, v129
  s_waitcnt lgkmcnt(3)
  v_mfma_f32_32x32x16_bf16 v[88:103], v[144:147], v[52:55], v[88:103]
  ds_read_b128 v[136:139], v236 offset:33792
  v_pk_mul_f16 v130, v122, v130
  v_pk_mul_f16 v131, v123, v131
  v_pk_mul_f16 v132, v124, v132
  v_pk_mul_f16 v133, v125, v133
  v_pk_mul_f16 v134, v126, v134
  v_pk_mul_f16 v135, v127, v135
  v_exp_f16_sdwa v128, -v128 dst_sel:WORD_0 dst_unused:UNUSED_PRESERVE src0_sel:WORD_0
  s_waitcnt lgkmcnt(3)
  v_mfma_f32_32x32x16_f16 v[16:31], v[148:151], v[112:115], v[16:31]
  ds_read_b128 v[140:143], v237 offset:29696
  v_exp_f16_sdwa v129, -v129 dst_sel:WORD_0 dst_unused:UNUSED_PRESERVE src0_sel:WORD_0
  v_exp_f16_sdwa v130, -v130 dst_sel:WORD_0 dst_unused:UNUSED_PRESERVE src0_sel:WORD_0
  v_exp_f16_sdwa v131, -v131 dst_sel:WORD_0 dst_unused:UNUSED_PRESERVE src0_sel:WORD_0
  v_exp_f16_sdwa v132, -v132 dst_sel:WORD_0 dst_unused:UNUSED_PRESERVE src0_sel:WORD_0
  v_exp_f16_sdwa v133, -v133 dst_sel:WORD_0 dst_unused:UNUSED_PRESERVE src0_sel:WORD_0
  s_waitcnt lgkmcnt(3)
  v_mfma_f32_32x32x16_bf16 v[88:103], v[152:155], v[56:59], v[88:103]
  ds_read_b128 v[144:147], v236 offset:34816
  v_exp_f16_sdwa v134, -v134 dst_sel:WORD_0 dst_unused:UNUSED_PRESERVE src0_sel:WORD_0
  v_exp_f16_sdwa v135, -v135 dst_sel:WORD_0 dst_unused:UNUSED_PRESERVE src0_sel:WORD_0
  v_exp_f16_sdwa v128, -v128 dst_sel:WORD_1 dst_unused:UNUSED_PRESERVE src0_sel:WORD_1
  v_exp_f16_sdwa v129, -v129 dst_sel:WORD_1 dst_unused:UNUSED_PRESERVE src0_sel:WORD_1
  s_waitcnt lgkmcnt(3)
  v_mfma_f32_32x32x16_f16 v[32:47], v[156:159], v[112:115], v[32:47]
  ds_read_b128 v[148:151], v237 offset:30720
  v_exp_f16_sdwa v130, -v130 dst_sel:WORD_1 dst_unused:UNUSED_PRESERVE src0_sel:WORD_1
  v_exp_f16_sdwa v131, -v131 dst_sel:WORD_1 dst_unused:UNUSED_PRESERVE src0_sel:WORD_1
  v_exp_f16_sdwa v132, -v132 dst_sel:WORD_1 dst_unused:UNUSED_PRESERVE src0_sel:WORD_1
  v_exp_f16_sdwa v133, -v133 dst_sel:WORD_1 dst_unused:UNUSED_PRESERVE src0_sel:WORD_1
  s_waitcnt lgkmcnt(3)
  v_mfma_f32_32x32x16_bf16 v[88:103], v[136:139], v[60:63], v[88:103]
  ds_read_b128 v[152:155], v236 offset:35840
  v_exp_f16_sdwa v134, -v134 dst_sel:WORD_1 dst_unused:UNUSED_PRESERVE src0_sel:WORD_1
  v_exp_f16_sdwa v135, -v135 dst_sel:WORD_1 dst_unused:UNUSED_PRESERVE src0_sel:WORD_1
  v_pk_fma_f16 v128, v128, s41, s41
  v_pk_fma_f16 v129, v129, s41, s41
  v_pk_fma_f16 v130, v130, s41, s41
  v_pk_fma_f16 v131, v131, s41, s41
  v_pk_fma_f16 v132, v132, s41, s41
  s_waitcnt lgkmcnt(3)
  v_mfma_f32_32x32x16_f16 v[0:15], v[140:143], v[116:119], v[0:15]
  ds_read_b128 v[156:159], v237 offset:31744
  v_pk_fma_f16 v133, v133, s41, s41
  v_pk_fma_f16 v134, v134, s41, s41
  v_pk_fma_f16 v135, v135, s41, s41
  v_rcp_f16_sdwa v128, v128 dst_sel:WORD_0 dst_unused:UNUSED_PRESERVE src0_sel:WORD_0
  v_rcp_f16_sdwa v129, v129 dst_sel:WORD_0 dst_unused:UNUSED_PRESERVE src0_sel:WORD_0
  v_rcp_f16_sdwa v130, v130 dst_sel:WORD_0 dst_unused:UNUSED_PRESERVE src0_sel:WORD_0
  s_waitcnt lgkmcnt(3)
  v_mfma_f32_32x32x16_bf16 v[88:103], v[144:147], v[64:67], v[88:103]
  ds_read_b128 v[136:139], v236 offset:36864
  v_rcp_f16_sdwa v131, v131 dst_sel:WORD_0 dst_unused:UNUSED_PRESERVE src0_sel:WORD_0
  v_rcp_f16_sdwa v132, v132 dst_sel:WORD_0 dst_unused:UNUSED_PRESERVE src0_sel:WORD_0
  v_rcp_f16_sdwa v133, v133 dst_sel:WORD_0 dst_unused:UNUSED_PRESERVE src0_sel:WORD_0
  v_rcp_f16_sdwa v134, v134 dst_sel:WORD_0 dst_unused:UNUSED_PRESERVE src0_sel:WORD_0
  s_waitcnt lgkmcnt(3)
  v_mfma_f32_32x32x16_f16 v[16:31], v[148:151], v[116:119], v[16:31]
  ds_read_b128 v[140:143], v237 offset:32768
  v_rcp_f16_sdwa v135, v135 dst_sel:WORD_0 dst_unused:UNUSED_PRESERVE src0_sel:WORD_0
  v_rcp_f16_sdwa v128, v128 dst_sel:WORD_1 dst_unused:UNUSED_PRESERVE src0_sel:WORD_1
  v_rcp_f16_sdwa v129, v129 dst_sel:WORD_1 dst_unused:UNUSED_PRESERVE src0_sel:WORD_1
  v_rcp_f16_sdwa v130, v130 dst_sel:WORD_1 dst_unused:UNUSED_PRESERVE src0_sel:WORD_1
  v_rcp_f16_sdwa v131, v131 dst_sel:WORD_1 dst_unused:UNUSED_PRESERVE src0_sel:WORD_1
  s_waitcnt lgkmcnt(3)
  v_mfma_f32_32x32x16_bf16 v[88:103], v[152:155], v[68:71], v[88:103]
  ds_read_b128 v[144:147], v236 offset:37888
  v_rcp_f16_sdwa v132, v132 dst_sel:WORD_1 dst_unused:UNUSED_PRESERVE src0_sel:WORD_1
  v_rcp_f16_sdwa v133, v133 dst_sel:WORD_1 dst_unused:UNUSED_PRESERVE src0_sel:WORD_1
  v_rcp_f16_sdwa v134, v134 dst_sel:WORD_1 dst_unused:UNUSED_PRESERVE src0_sel:WORD_1
  v_rcp_f16_sdwa v135, v135 dst_sel:WORD_1 dst_unused:UNUSED_PRESERVE src0_sel:WORD_1
  s_waitcnt lgkmcnt(3)
  v_mfma_f32_32x32x16_f16 v[32:47], v[156:159], v[116:119], v[32:47]
  ds_read_b128 v[148:151], v237 offset:33792
  v_pk_mul_f16 v104, v120, v128
  v_pk_mul_f16 v105, v121, v129
  v_pk_mul_f16 v106, v122, v130
  v_pk_mul_f16 v107, v123, v131
  v_pk_mul_f16 v108, v124, v132
  v_pk_mul_f16 v109, v125, v133
  v_pk_mul_f16 v110, v126, v134
  v_pk_mul_f16 v111, v127, v135
  s_waitcnt lgkmcnt(3)
  v_mfma_f32_32x32x16_bf16 v[72:87], v[136:139], v[48:51], 0
  ds_read_b128 v[152:155], v236 offset:38912
  v_cvt_pk_f16_f32 v120, v88, v89
  v_cvt_pk_f16_f32 v121, v90, v91
  v_cvt_pk_f16_f32 v122, v92, v93
  v_cvt_pk_f16_f32 v123, v94, v95
  v_cvt_pk_f16_f32 v124, v96, v97
  v_cvt_pk_f16_f32 v125, v98, v99
  v_cvt_pk_f16_f32 v126, v100, v101
  v_cvt_pk_f16_f32 v127, v102, v103
  v_pk_fma_f16 v128, v120, v120, s40
  s_waitcnt lgkmcnt(3)
  v_mfma_f32_32x32x16_f16 v[0:15], v[140:143], v[104:107], v[0:15]
  ds_read_b128 v[156:159], v237 offset:34816
  v_pk_fma_f16 v129, v121, v121, s40
  v_pk_fma_f16 v130, v122, v122, s40
  v_pk_fma_f16 v131, v123, v123, s40
  v_pk_fma_f16 v132, v124, v124, s40
  v_pk_fma_f16 v133, v125, v125, s40
  v_pk_fma_f16 v134, v126, v126, s40
  v_pk_fma_f16 v135, v127, v127, s40
  v_pk_mul_f16 v128, v120, v128
  v_pk_mul_f16 v129, v121, v129
  s_waitcnt lgkmcnt(3)
  v_mfma_f32_32x32x16_bf16 v[72:87], v[144:147], v[52:55], v[72:87]
  ds_read_b128 v[136:139], v236 offset:39936
  v_pk_mul_f16 v130, v122, v130
  v_pk_mul_f16 v131, v123, v131
  v_pk_mul_f16 v132, v124, v132
  v_pk_mul_f16 v133, v125, v133
  v_pk_mul_f16 v134, v126, v134
  v_pk_mul_f16 v135, v127, v135
  v_exp_f16_sdwa v128, -v128 dst_sel:WORD_0 dst_unused:UNUSED_PRESERVE src0_sel:WORD_0
  s_waitcnt lgkmcnt(3)
  v_mfma_f32_32x32x16_f16 v[16:31], v[148:151], v[104:107], v[16:31]
  ds_read_b128 v[140:143], v237 offset:35840
  v_exp_f16_sdwa v129, -v129 dst_sel:WORD_0 dst_unused:UNUSED_PRESERVE src0_sel:WORD_0
  v_exp_f16_sdwa v130, -v130 dst_sel:WORD_0 dst_unused:UNUSED_PRESERVE src0_sel:WORD_0
  v_exp_f16_sdwa v131, -v131 dst_sel:WORD_0 dst_unused:UNUSED_PRESERVE src0_sel:WORD_0
  v_exp_f16_sdwa v132, -v132 dst_sel:WORD_0 dst_unused:UNUSED_PRESERVE src0_sel:WORD_0
  v_exp_f16_sdwa v133, -v133 dst_sel:WORD_0 dst_unused:UNUSED_PRESERVE src0_sel:WORD_0
  s_waitcnt lgkmcnt(3)
  v_mfma_f32_32x32x16_bf16 v[72:87], v[152:155], v[56:59], v[72:87]
  ds_read_b128 v[144:147], v236 offset:40960
  v_exp_f16_sdwa v134, -v134 dst_sel:WORD_0 dst_unused:UNUSED_PRESERVE src0_sel:WORD_0
  v_exp_f16_sdwa v135, -v135 dst_sel:WORD_0 dst_unused:UNUSED_PRESERVE src0_sel:WORD_0
  v_exp_f16_sdwa v128, -v128 dst_sel:WORD_1 dst_unused:UNUSED_PRESERVE src0_sel:WORD_1
  v_exp_f16_sdwa v129, -v129 dst_sel:WORD_1 dst_unused:UNUSED_PRESERVE src0_sel:WORD_1
  s_waitcnt lgkmcnt(3)
  v_mfma_f32_32x32x16_f16 v[32:47], v[156:159], v[104:107], v[32:47]
  ds_read_b128 v[148:151], v237 offset:36864
  v_exp_f16_sdwa v130, -v130 dst_sel:WORD_1 dst_unused:UNUSED_PRESERVE src0_sel:WORD_1
  v_exp_f16_sdwa v131, -v131 dst_sel:WORD_1 dst_unused:UNUSED_PRESERVE src0_sel:WORD_1
  v_exp_f16_sdwa v132, -v132 dst_sel:WORD_1 dst_unused:UNUSED_PRESERVE src0_sel:WORD_1
  v_exp_f16_sdwa v133, -v133 dst_sel:WORD_1 dst_unused:UNUSED_PRESERVE src0_sel:WORD_1
  s_waitcnt lgkmcnt(3)
  v_mfma_f32_32x32x16_bf16 v[72:87], v[136:139], v[60:63], v[72:87]
  ds_read_b128 v[152:155], v236 offset:41984
  v_exp_f16_sdwa v134, -v134 dst_sel:WORD_1 dst_unused:UNUSED_PRESERVE src0_sel:WORD_1
  v_exp_f16_sdwa v135, -v135 dst_sel:WORD_1 dst_unused:UNUSED_PRESERVE src0_sel:WORD_1
  v_pk_fma_f16 v128, v128, s41, s41
  v_pk_fma_f16 v129, v129, s41, s41
  v_pk_fma_f16 v130, v130, s41, s41
  v_pk_fma_f16 v131, v131, s41, s41
  v_pk_fma_f16 v132, v132, s41, s41
  s_waitcnt lgkmcnt(3)
  v_mfma_f32_32x32x16_f16 v[0:15], v[140:143], v[108:111], v[0:15]
  ds_read_b128 v[156:159], v237 offset:37888
  v_pk_fma_f16 v133, v133, s41, s41
  v_pk_fma_f16 v134, v134, s41, s41
  v_pk_fma_f16 v135, v135, s41, s41
  v_rcp_f16_sdwa v128, v128 dst_sel:WORD_0 dst_unused:UNUSED_PRESERVE src0_sel:WORD_0
  v_rcp_f16_sdwa v129, v129 dst_sel:WORD_0 dst_unused:UNUSED_PRESERVE src0_sel:WORD_0
  v_rcp_f16_sdwa v130, v130 dst_sel:WORD_0 dst_unused:UNUSED_PRESERVE src0_sel:WORD_0
  s_waitcnt lgkmcnt(3)
  v_mfma_f32_32x32x16_bf16 v[72:87], v[144:147], v[64:67], v[72:87]
  ds_read_b128 v[136:139], v236 offset:43008
  v_rcp_f16_sdwa v131, v131 dst_sel:WORD_0 dst_unused:UNUSED_PRESERVE src0_sel:WORD_0
  v_rcp_f16_sdwa v132, v132 dst_sel:WORD_0 dst_unused:UNUSED_PRESERVE src0_sel:WORD_0
  v_rcp_f16_sdwa v133, v133 dst_sel:WORD_0 dst_unused:UNUSED_PRESERVE src0_sel:WORD_0
  v_rcp_f16_sdwa v134, v134 dst_sel:WORD_0 dst_unused:UNUSED_PRESERVE src0_sel:WORD_0
  s_waitcnt lgkmcnt(3)
  v_mfma_f32_32x32x16_f16 v[16:31], v[148:151], v[108:111], v[16:31]
  ds_read_b128 v[140:143], v237 offset:38912
  v_rcp_f16_sdwa v135, v135 dst_sel:WORD_0 dst_unused:UNUSED_PRESERVE src0_sel:WORD_0
  v_rcp_f16_sdwa v128, v128 dst_sel:WORD_1 dst_unused:UNUSED_PRESERVE src0_sel:WORD_1
  v_rcp_f16_sdwa v129, v129 dst_sel:WORD_1 dst_unused:UNUSED_PRESERVE src0_sel:WORD_1
  v_rcp_f16_sdwa v130, v130 dst_sel:WORD_1 dst_unused:UNUSED_PRESERVE src0_sel:WORD_1
  v_rcp_f16_sdwa v131, v131 dst_sel:WORD_1 dst_unused:UNUSED_PRESERVE src0_sel:WORD_1
  s_waitcnt lgkmcnt(3)
  v_mfma_f32_32x32x16_bf16 v[72:87], v[152:155], v[68:71], v[72:87]
  ds_read_b128 v[144:147], v236 offset:44032
  v_rcp_f16_sdwa v132, v132 dst_sel:WORD_1 dst_unused:UNUSED_PRESERVE src0_sel:WORD_1
  v_rcp_f16_sdwa v133, v133 dst_sel:WORD_1 dst_unused:UNUSED_PRESERVE src0_sel:WORD_1
  v_rcp_f16_sdwa v134, v134 dst_sel:WORD_1 dst_unused:UNUSED_PRESERVE src0_sel:WORD_1
  v_rcp_f16_sdwa v135, v135 dst_sel:WORD_1 dst_unused:UNUSED_PRESERVE src0_sel:WORD_1
  s_waitcnt lgkmcnt(3)
  v_mfma_f32_32x32x16_f16 v[32:47], v[156:159], v[108:111], v[32:47]
  ds_read_b128 v[148:151], v237 offset:39936
  v_pk_mul_f16 v112, v120, v128
  v_pk_mul_f16 v113, v121, v129
  v_pk_mul_f16 v114, v122, v130
  v_pk_mul_f16 v115, v123, v131
  v_pk_mul_f16 v116, v124, v132
  v_pk_mul_f16 v117, v125, v133
  v_pk_mul_f16 v118, v126, v134
  v_pk_mul_f16 v119, v127, v135
  s_waitcnt lgkmcnt(3)
  v_mfma_f32_32x32x16_bf16 v[88:103], v[136:139], v[48:51], 0
  ds_read_b128 v[152:155], v236 offset:45056
  v_cvt_pk_f16_f32 v120, v72, v73
  v_cvt_pk_f16_f32 v121, v74, v75
  v_cvt_pk_f16_f32 v122, v76, v77
  v_cvt_pk_f16_f32 v123, v78, v79
  v_cvt_pk_f16_f32 v124, v80, v81
  v_cvt_pk_f16_f32 v125, v82, v83
  v_cvt_pk_f16_f32 v126, v84, v85
  v_cvt_pk_f16_f32 v127, v86, v87
  v_pk_fma_f16 v128, v120, v120, s40
  s_waitcnt lgkmcnt(3)
  v_mfma_f32_32x32x16_f16 v[0:15], v[140:143], v[112:115], v[0:15]
  ds_read_b128 v[156:159], v237 offset:40960
  v_pk_fma_f16 v129, v121, v121, s40
  v_pk_fma_f16 v130, v122, v122, s40
  v_pk_fma_f16 v131, v123, v123, s40
  v_pk_fma_f16 v132, v124, v124, s40
  v_pk_fma_f16 v133, v125, v125, s40
  v_pk_fma_f16 v134, v126, v126, s40
  v_pk_fma_f16 v135, v127, v127, s40
  v_pk_mul_f16 v128, v120, v128
  v_pk_mul_f16 v129, v121, v129
  s_waitcnt lgkmcnt(3)
  v_mfma_f32_32x32x16_bf16 v[88:103], v[144:147], v[52:55], v[88:103]
  ds_read_b128 v[136:139], v236 offset:46080
  v_pk_mul_f16 v130, v122, v130
  v_pk_mul_f16 v131, v123, v131
  v_pk_mul_f16 v132, v124, v132
  v_pk_mul_f16 v133, v125, v133
  v_pk_mul_f16 v134, v126, v134
  v_pk_mul_f16 v135, v127, v135
  v_exp_f16_sdwa v128, -v128 dst_sel:WORD_0 dst_unused:UNUSED_PRESERVE src0_sel:WORD_0
  s_waitcnt lgkmcnt(3)
  v_mfma_f32_32x32x16_f16 v[16:31], v[148:151], v[112:115], v[16:31]
  ds_read_b128 v[140:143], v237 offset:41984
  v_exp_f16_sdwa v129, -v129 dst_sel:WORD_0 dst_unused:UNUSED_PRESERVE src0_sel:WORD_0
  v_exp_f16_sdwa v130, -v130 dst_sel:WORD_0 dst_unused:UNUSED_PRESERVE src0_sel:WORD_0
  v_exp_f16_sdwa v131, -v131 dst_sel:WORD_0 dst_unused:UNUSED_PRESERVE src0_sel:WORD_0
  v_exp_f16_sdwa v132, -v132 dst_sel:WORD_0 dst_unused:UNUSED_PRESERVE src0_sel:WORD_0
  v_exp_f16_sdwa v133, -v133 dst_sel:WORD_0 dst_unused:UNUSED_PRESERVE src0_sel:WORD_0
  s_waitcnt lgkmcnt(3)
  v_mfma_f32_32x32x16_bf16 v[88:103], v[152:155], v[56:59], v[88:103]
  ds_read_b128 v[144:147], v236 offset:47104
  v_exp_f16_sdwa v134, -v134 dst_sel:WORD_0 dst_unused:UNUSED_PRESERVE src0_sel:WORD_0
  v_exp_f16_sdwa v135, -v135 dst_sel:WORD_0 dst_unused:UNUSED_PRESERVE src0_sel:WORD_0
  v_exp_f16_sdwa v128, -v128 dst_sel:WORD_1 dst_unused:UNUSED_PRESERVE src0_sel:WORD_1
  v_exp_f16_sdwa v129, -v129 dst_sel:WORD_1 dst_unused:UNUSED_PRESERVE src0_sel:WORD_1
  s_waitcnt lgkmcnt(3)
  v_mfma_f32_32x32x16_f16 v[32:47], v[156:159], v[112:115], v[32:47]
  ds_read_b128 v[148:151], v237 offset:43008
  v_exp_f16_sdwa v130, -v130 dst_sel:WORD_1 dst_unused:UNUSED_PRESERVE src0_sel:WORD_1
  v_exp_f16_sdwa v131, -v131 dst_sel:WORD_1 dst_unused:UNUSED_PRESERVE src0_sel:WORD_1
  v_exp_f16_sdwa v132, -v132 dst_sel:WORD_1 dst_unused:UNUSED_PRESERVE src0_sel:WORD_1
  v_exp_f16_sdwa v133, -v133 dst_sel:WORD_1 dst_unused:UNUSED_PRESERVE src0_sel:WORD_1
  s_waitcnt lgkmcnt(3)
  v_mfma_f32_32x32x16_bf16 v[88:103], v[136:139], v[60:63], v[88:103]
  ds_read_b128 v[152:155], v236 offset:48128
  v_exp_f16_sdwa v134, -v134 dst_sel:WORD_1 dst_unused:UNUSED_PRESERVE src0_sel:WORD_1
  v_exp_f16_sdwa v135, -v135 dst_sel:WORD_1 dst_unused:UNUSED_PRESERVE src0_sel:WORD_1
  v_pk_fma_f16 v128, v128, s41, s41
  v_pk_fma_f16 v129, v129, s41, s41
  v_pk_fma_f16 v130, v130, s41, s41
  v_pk_fma_f16 v131, v131, s41, s41
  v_pk_fma_f16 v132, v132, s41, s41
  s_waitcnt lgkmcnt(3)
  v_mfma_f32_32x32x16_f16 v[0:15], v[140:143], v[116:119], v[0:15]
  ds_read_b128 v[156:159], v237 offset:44032
  v_pk_fma_f16 v133, v133, s41, s41
  v_pk_fma_f16 v134, v134, s41, s41
  v_pk_fma_f16 v135, v135, s41, s41
  v_rcp_f16_sdwa v128, v128 dst_sel:WORD_0 dst_unused:UNUSED_PRESERVE src0_sel:WORD_0
  v_rcp_f16_sdwa v129, v129 dst_sel:WORD_0 dst_unused:UNUSED_PRESERVE src0_sel:WORD_0
  v_rcp_f16_sdwa v130, v130 dst_sel:WORD_0 dst_unused:UNUSED_PRESERVE src0_sel:WORD_0
  s_waitcnt lgkmcnt(3)
  v_mfma_f32_32x32x16_bf16 v[88:103], v[144:147], v[64:67], v[88:103]
  s_cmp_lg_u32 s47, 1
  s_cbranch_scc1 L_nob1
  s_barrier
  s_mov_b32 s47, 0
L_nob1:
  ds_read_b128 v[136:139], v236 offset:49152
  v_rcp_f16_sdwa v131, v131 dst_sel:WORD_0 dst_unused:UNUSED_PRESERVE src0_sel:WORD_0
  v_rcp_f16_sdwa v132, v132 dst_sel:WORD_0 dst_unused:UNUSED_PRESERVE src0_sel:WORD_0
  v_rcp_f16_sdwa v133, v133 dst_sel:WORD_0 dst_unused:UNUSED_PRESERVE src0_sel:WORD_0
  v_rcp_f16_sdwa v134, v134 dst_sel:WORD_0 dst_unused:UNUSED_PRESERVE src0_sel:WORD_0
  s_waitcnt lgkmcnt(3)
  v_mfma_f32_32x32x16_f16 v[16:31], v[148:151], v[116:119], v[16:31]
  ds_read_b128 v[140:143], v237 offset:45056
  v_rcp_f16_sdwa v135, v135 dst_sel:WORD_0 dst_unused:UNUSED_PRESERVE src0_sel:WORD_0
  v_rcp_f16_sdwa v128, v128 dst_sel:WORD_1 dst_unused:UNUSED_PRESERVE src0_sel:WORD_1
  v_rcp_f16_sdwa v129, v129 dst_sel:WORD_1 dst_unused:UNUSED_PRESERVE src0_sel:WORD_1
  v_rcp_f16_sdwa v130, v130 dst_sel:WORD_1 dst_unused:UNUSED_PRESERVE src0_sel:WORD_1
  v_rcp_f16_sdwa v131, v131 dst_sel:WORD_1 dst_unused:UNUSED_PRESERVE src0_sel:WORD_1
  s_waitcnt lgkmcnt(3)
  v_mfma_f32_32x32x16_bf16 v[88:103], v[152:155], v[68:71], v[88:103]
  ds_read_b128 v[144:147], v236 offset:50176
  v_rcp_f16_sdwa v132, v132 dst_sel:WORD_1 dst_unused:UNUSED_PRESERVE src0_sel:WORD_1
  v_rcp_f16_sdwa v133, v133 dst_sel:WORD_1 dst_unused:UNUSED_PRESERVE src0_sel:WORD_1
  v_rcp_f16_sdwa v134, v134 dst_sel:WORD_1 dst_unused:UNUSED_PRESERVE src0_sel:WORD_1
  v_rcp_f16_sdwa v135, v135 dst_sel:WORD_1 dst_unused:UNUSED_PRESERVE src0_sel:WORD_1
  s_waitcnt lgkmcnt(3)
  v_mfma_f32_32x32x16_f16 v[32:47], v[156:159], v[116:119], v[32:47]
  ds_read_b128 v[148:151], v237 offset:46080
  v_pk_mul_f16 v104, v120, v128
  v_pk_mul_f16 v105, v121, v129
  v_pk_mul_f16 v106, v122, v130
  v_pk_mul_f16 v107, v123, v131
  v_pk_mul_f16 v108, v124, v132
  v_pk_mul_f16 v109, v125, v133
  v_pk_mul_f16 v110, v126, v134
  v_pk_mul_f16 v111, v127, v135
  s_waitcnt lgkmcnt(3)
  v_mfma_f32_32x32x16_bf16 v[72:87], v[136:139], v[48:51], 0
  ds_read_b128 v[152:155], v236 offset:51200
  v_cvt_pk_f16_f32 v120, v88, v89
  v_cvt_pk_f16_f32 v121, v90, v91
  v_cvt_pk_f16_f32 v122, v92, v93
  v_cvt_pk_f16_f32 v123, v94, v95
  v_cvt_pk_f16_f32 v124, v96, v97
  v_cvt_pk_f16_f32 v125, v98, v99
  v_cvt_pk_f16_f32 v126, v100, v101
  v_cvt_pk_f16_f32 v127, v102, v103
  v_pk_fma_f16 v128, v120, v120, s40
  s_waitcnt lgkmcnt(3)
  v_mfma_f32_32x32x16_f16 v[0:15], v[140:143], v[104:107], v[0:15]
  ds_read_b128 v[156:159], v237 offset:47104
  v_pk_fma_f16 v129, v121, v121, s40
  v_pk_fma_f16 v130, v122, v122, s40
  v_pk_fma_f16 v131, v123, v123, s40
  v_pk_fma_f16 v132, v124, v124, s40
  v_pk_fma_f16 v133, v125, v125, s40
  v_pk_fma_f16 v134, v126, v126, s40
  v_pk_fma_f16 v135, v127, v127, s40
  v_pk_mul_f16 v128, v120, v128
  v_pk_mul_f16 v129, v121, v129
  s_waitcnt lgkmcnt(3)
  v_mfma_f32_32x32x16_bf16 v[72:87], v[144:147], v[52:55], v[72:87]
  ds_read_b128 v[136:139], v236 offset:52224
  v_pk_mul_f16 v130, v122, v130
  v_pk_mul_f16 v131, v123, v131
  v_pk_mul_f16 v132, v124, v132
  v_pk_mul_f16 v133, v125, v133
  v_pk_mul_f16 v134, v126, v134
  v_pk_mul_f16 v135, v127, v135
  v_exp_f16_sdwa v128, -v128 dst_sel:WORD_0 dst_unused:UNUSED_PRESERVE src0_sel:WORD_0
  s_waitcnt lgkmcnt(3)
  v_mfma_f32_32x32x16_f16 v[16:31], v[148:151], v[104:107], v[16:31]
  ds_read_b128 v[140:143], v237 offset:48128
  v_exp_f16_sdwa v129, -v129 dst_sel:WORD_0 dst_unused:UNUSED_PRESERVE src0_sel:WORD_0
  v_exp_f16_sdwa v130, -v130 dst_sel:WORD_0 dst_unused:UNUSED_PRESERVE src0_sel:WORD_0
  v_exp_f16_sdwa v131, -v131 dst_sel:WORD_0 dst_unused:UNUSED_PRESERVE src0_sel:WORD_0
  v_exp_f16_sdwa v132, -v132 dst_sel:WORD_0 dst_unused:UNUSED_PRESERVE src0_sel:WORD_0
  v_exp_f16_sdwa v133, -v133 dst_sel:WORD_0 dst_unused:UNUSED_PRESERVE src0_sel:WORD_0
  s_waitcnt lgkmcnt(3)
  v_mfma_f32_32x32x16_bf16 v[72:87], v[152:155], v[56:59], v[72:87]
  ds_read_b128 v[144:147], v236 offset:53248
  v_exp_f16_sdwa v134, -v134 dst_sel:WORD_0 dst_unused:UNUSED_PRESERVE src0_sel:WORD_0
  v_exp_f16_sdwa v135, -v135 dst_sel:WORD_0 dst_unused:UNUSED_PRESERVE src0_sel:WORD_0
  v_exp_f16_sdwa v128, -v128 dst_sel:WORD_1 dst_unused:UNUSED_PRESERVE src0_sel:WORD_1
  v_exp_f16_sdwa v129, -v129 dst_sel:WORD_1 dst_unused:UNUSED_PRESERVE src0_sel:WORD_1
  s_waitcnt lgkmcnt(3)
  v_mfma_f32_32x32x16_f16 v[32:47], v[156:159], v[104:107], v[32:47]
  ds_read_b128 v[148:151], v237 offset:49152
  v_exp_f16_sdwa v130, -v130 dst_sel:WORD_1 dst_unused:UNUSED_PRESERVE src0_sel:WORD_1
  v_exp_f16_sdwa v131, -v131 dst_sel:WORD_1 dst_unused:UNUSED_PRESERVE src0_sel:WORD_1
  v_exp_f16_sdwa v132, -v132 dst_sel:WORD_1 dst_unused:UNUSED_PRESERVE src0_sel:WORD_1
  v_exp_f16_sdwa v133, -v133 dst_sel:WORD_1 dst_unused:UNUSED_PRESERVE src0_sel:WORD_1
  s_waitcnt lgkmcnt(3)
  v_mfma_f32_32x32x16_bf16 v[72:87], v[136:139], v[60:63], v[72:87]
  ds_read_b128 v[152:155], v236 offset:54272
  v_exp_f16_sdwa v134, -v134 dst_sel:WORD_1 dst_unused:UNUSED_PRESERVE src0_sel:WORD_1
  v_exp_f16_sdwa v135, -v135 dst_sel:WORD_1 dst_unused:UNUSED_PRESERVE src0_sel:WORD_1
  v_pk_fma_f16 v128, v128, s41, s41
  v_pk_fma_f16 v129, v129, s41, s41
  v_pk_fma_f16 v130, v130, s41, s41
  v_pk_fma_f16 v131, v131, s41, s41
  v_pk_fma_f16 v132, v132, s41, s41
  s_waitcnt lgkmcnt(3)
  v_mfma_f32_32x32x16_f16 v[0:15], v[140:143], v[108:111], v[0:15]
  ds_read_b128 v[156:159], v237 offset:50176
  v_pk_fma_f16 v133, v133, s41, s41
  v_pk_fma_f16 v134, v134, s41, s41
  v_pk_fma_f16 v135, v135, s41, s41
  v_rcp_f16_sdwa v128, v128 dst_sel:WORD_0 dst_unused:UNUSED_PRESERVE src0_sel:WORD_0
  v_rcp_f16_sdwa v129, v129 dst_sel:WORD_0 dst_unused:UNUSED_PRESERVE src0_sel:WORD_0
  v_rcp_f16_sdwa v130, v130 dst_sel:WORD_0 dst_unused:UNUSED_PRESERVE src0_sel:WORD_0
  s_waitcnt lgkmcnt(3)
  v_mfma_f32_32x32x16_bf16 v[72:87], v[144:147], v[64:67], v[72:87]
  ds_read_b128 v[136:139], v236 offset:55296
  v_rcp_f16_sdwa v131, v131 dst_sel:WORD_0 dst_unused:UNUSED_PRESERVE src0_sel:WORD_0
  v_rcp_f16_sdwa v132, v132 dst_sel:WORD_0 dst_unused:UNUSED_PRESERVE src0_sel:WORD_0
  v_rcp_f16_sdwa v133, v133 dst_sel:WORD_0 dst_unused:UNUSED_PRESERVE src0_sel:WORD_0
  v_rcp_f16_sdwa v134, v134 dst_sel:WORD_0 dst_unused:UNUSED_PRESERVE src0_sel:WORD_0
  s_waitcnt lgkmcnt(3)
  v_mfma_f32_32x32x16_f16 v[16:31], v[148:151], v[108:111], v[16:31]
  ds_read_b128 v[140:143], v237 offset:51200
  v_rcp_f16_sdwa v135, v135 dst_sel:WORD_0 dst_unused:UNUSED_PRESERVE src0_sel:WORD_0
  v_rcp_f16_sdwa v128, v128 dst_sel:WORD_1 dst_unused:UNUSED_PRESERVE src0_sel:WORD_1
  v_rcp_f16_sdwa v129, v129 dst_sel:WORD_1 dst_unused:UNUSED_PRESERVE src0_sel:WORD_1
  v_rcp_f16_sdwa v130, v130 dst_sel:WORD_1 dst_unused:UNUSED_PRESERVE src0_sel:WORD_1
  v_rcp_f16_sdwa v131, v131 dst_sel:WORD_1 dst_unused:UNUSED_PRESERVE src0_sel:WORD_1
  s_waitcnt lgkmcnt(3)
  v_mfma_f32_32x32x16_bf16 v[72:87], v[152:155], v[68:71], v[72:87]
  ds_read_b128 v[144:147], v236 offset:56320
  v_rcp_f16_sdwa v132, v132 dst_sel:WORD_1 dst_unused:UNUSED_PRESERVE src0_sel:WORD_1
  v_rcp_f16_sdwa v133, v133 dst_sel:WORD_1 dst_unused:UNUSED_PRESERVE src0_sel:WORD_1
  v_rcp_f16_sdwa v134, v134 dst_sel:WORD_1 dst_unused:UNUSED_PRESERVE src0_sel:WORD_1
  v_rcp_f16_sdwa v135, v135 dst_sel:WORD_1 dst_unused:UNUSED_PRESERVE src0_sel:WORD_1
  s_waitcnt lgkmcnt(3)
  v_mfma_f32_32x32x16_f16 v[32:47], v[156:159], v[108:111], v[32:47]
  ds_read_b128 v[148:151], v237 offset:52224
  v_pk_mul_f16 v112, v120, v128
  v_pk_mul_f16 v113, v121, v129
  v_pk_mul_f16 v114, v122, v130
  v_pk_mul_f16 v115, v123, v131
  v_pk_mul_f16 v116, v124, v132
  v_pk_mul_f16 v117, v125, v133
  v_pk_mul_f16 v118, v126, v134
  v_pk_mul_f16 v119, v127, v135
  s_waitcnt lgkmcnt(3)
  v_mfma_f32_32x32x16_bf16 v[88:103], v[136:139], v[48:51], 0
  ds_read_b128 v[152:155], v236 offset:57344
  v_cvt_pk_f16_f32 v120, v72, v73
  v_cvt_pk_f16_f32 v121, v74, v75
  v_cvt_pk_f16_f32 v122, v76, v77
  v_cvt_pk_f16_f32 v123, v78, v79
  v_cvt_pk_f16_f32 v124, v80, v81
  v_cvt_pk_f16_f32 v125, v82, v83
  v_cvt_pk_f16_f32 v126, v84, v85
  v_cvt_pk_f16_f32 v127, v86, v87
  v_pk_fma_f16 v128, v120, v120, s40
  s_waitcnt lgkmcnt(3)
  v_mfma_f32_32x32x16_f16 v[0:15], v[140:143], v[112:115], v[0:15]
  ds_read_b128 v[156:159], v237 offset:53248
  v_pk_fma_f16 v129, v121, v121, s40
  v_pk_fma_f16 v130, v122, v122, s40
  v_pk_fma_f16 v131, v123, v123, s40
  v_pk_fma_f16 v132, v124, v124, s40
  v_pk_fma_f16 v133, v125, v125, s40
  v_pk_fma_f16 v134, v126, v126, s40
  v_pk_fma_f16 v135, v127, v127, s40
  v_pk_mul_f16 v128, v120, v128
  v_pk_mul_f16 v129, v121, v129
  s_waitcnt lgkmcnt(3)
  v_mfma_f32_32x32x16_bf16 v[88:103], v[144:147], v[52:55], v[88:103]
  ds_read_b128 v[136:139], v236 offset:58368
  v_pk_mul_f16 v130, v122, v130
  v_pk_mul_f16 v131, v123, v131
  v_pk_mul_f16 v132, v124, v132
  v_pk_mul_f16 v133, v125, v133
  v_pk_mul_f16 v134, v126, v134
  v_pk_mul_f16 v135, v127, v135
  v_exp_f16_sdwa v128, -v128 dst_sel:WORD_0 dst_unused:UNUSED_PRESERVE src0_sel:WORD_0
  s_waitcnt lgkmcnt(3)
  v_mfma_f32_32x32x16_f16 v[16:31], v[148:151], v[112:115], v[16:31]
  ds_read_b128 v[140:143], v237 offset:54272
  v_exp_f16_sdwa v129, -v129 dst_sel:WORD_0 dst_unused:UNUSED_PRESERVE src0_sel:WORD_0
  v_exp_f16_sdwa v130, -v130 dst_sel:WORD_0 dst_unused:UNUSED_PRESERVE src0_sel:WORD_0
  v_exp_f16_sdwa v131, -v131 dst_sel:WORD_0 dst_unused:UNUSED_PRESERVE src0_sel:WORD_0
  v_exp_f16_sdwa v132, -v132 dst_sel:WORD_0 dst_unused:UNUSED_PRESERVE src0_sel:WORD_0
  v_exp_f16_sdwa v133, -v133 dst_sel:WORD_0 dst_unused:UNUSED_PRESERVE src0_sel:WORD_0
  s_waitcnt lgkmcnt(3)
  v_mfma_f32_32x32x16_bf16 v[88:103], v[152:155], v[56:59], v[88:103]
  ds_read_b128 v[144:147], v236 offset:59392
  v_exp_f16_sdwa v134, -v134 dst_sel:WORD_0 dst_unused:UNUSED_PRESERVE src0_sel:WORD_0
  v_exp_f16_sdwa v135, -v135 dst_sel:WORD_0 dst_unused:UNUSED_PRESERVE src0_sel:WORD_0
  v_exp_f16_sdwa v128, -v128 dst_sel:WORD_1 dst_unused:UNUSED_PRESERVE src0_sel:WORD_1
  v_exp_f16_sdwa v129, -v129 dst_sel:WORD_1 dst_unused:UNUSED_PRESERVE src0_sel:WORD_1
  s_waitcnt lgkmcnt(3)
  v_mfma_f32_32x32x16_f16 v[32:47], v[156:159], v[112:115], v[32:47]
  ds_read_b128 v[148:151], v237 offset:55296
  v_exp_f16_sdwa v130, -v130 dst_sel:WORD_1 dst_unused:UNUSED_PRESERVE src0_sel:WORD_1
  v_exp_f16_sdwa v131, -v131 dst_sel:WORD_1 dst_unused:UNUSED_PRESERVE src0_sel:WORD_1
  v_exp_f16_sdwa v132, -v132 dst_sel:WORD_1 dst_unused:UNUSED_PRESERVE src0_sel:WORD_1
  v_exp_f16_sdwa v133, -v133 dst_sel:WORD_1 dst_unused:UNUSED_PRESERVE src0_sel:WORD_1
  s_waitcnt lgkmcnt(3)
  v_mfma_f32_32x32x16_bf16 v[88:103], v[136:139], v[60:63], v[88:103]
  ds_read_b128 v[152:155], v236 offset:60416
  v_exp_f16_sdwa v134, -v134 dst_sel:WORD_1 dst_unused:UNUSED_PRESERVE src0_sel:WORD_1
  v_exp_f16_sdwa v135, -v135 dst_sel:WORD_1 dst_unused:UNUSED_PRESERVE src0_sel:WORD_1
  v_pk_fma_f16 v128, v128, s41, s41
  v_pk_fma_f16 v129, v129, s41, s41
  v_pk_fma_f16 v130, v130, s41, s41
  v_pk_fma_f16 v131, v131, s41, s41
  v_pk_fma_f16 v132, v132, s41, s41
  s_waitcnt lgkmcnt(3)
  v_mfma_f32_32x32x16_f16 v[0:15], v[140:143], v[116:119], v[0:15]
  ds_read_b128 v[156:159], v237 offset:56320
  v_pk_fma_f16 v133, v133, s41, s41
  v_pk_fma_f16 v134, v134, s41, s41
  v_pk_fma_f16 v135, v135, s41, s41
  v_rcp_f16_sdwa v128, v128 dst_sel:WORD_0 dst_unused:UNUSED_PRESERVE src0_sel:WORD_0
  v_rcp_f16_sdwa v129, v129 dst_sel:WORD_0 dst_unused:UNUSED_PRESERVE src0_sel:WORD_0
  v_rcp_f16_sdwa v130, v130 dst_sel:WORD_0 dst_unused:UNUSED_PRESERVE src0_sel:WORD_0
  s_waitcnt lgkmcnt(3)
  v_mfma_f32_32x32x16_bf16 v[88:103], v[144:147], v[64:67], v[88:103]
  ds_read_b128 v[136:139], v236 offset:61440
  v_rcp_f16_sdwa v131, v131 dst_sel:WORD_0 dst_unused:UNUSED_PRESERVE src0_sel:WORD_0
  v_rcp_f16_sdwa v132, v132 dst_sel:WORD_0 dst_unused:UNUSED_PRESERVE src0_sel:WORD_0
  v_rcp_f16_sdwa v133, v133 dst_sel:WORD_0 dst_unused:UNUSED_PRESERVE src0_sel:WORD_0
  v_rcp_f16_sdwa v134, v134 dst_sel:WORD_0 dst_unused:UNUSED_PRESERVE src0_sel:WORD_0
  s_waitcnt lgkmcnt(3)
  v_mfma_f32_32x32x16_f16 v[16:31], v[148:151], v[116:119], v[16:31]
  ds_read_b128 v[140:143], v237 offset:57344
  v_rcp_f16_sdwa v135, v135 dst_sel:WORD_0 dst_unused:UNUSED_PRESERVE src0_sel:WORD_0
  v_rcp_f16_sdwa v128, v128 dst_sel:WORD_1 dst_unused:UNUSED_PRESERVE src0_sel:WORD_1
  v_rcp_f16_sdwa v129, v129 dst_sel:WORD_1 dst_unused:UNUSED_PRESERVE src0_sel:WORD_1
  v_rcp_f16_sdwa v130, v130 dst_sel:WORD_1 dst_unused:UNUSED_PRESERVE src0_sel:WORD_1
  v_rcp_f16_sdwa v131, v131 dst_sel:WORD_1 dst_unused:UNUSED_PRESERVE src0_sel:WORD_1
  s_waitcnt lgkmcnt(3)
  v_mfma_f32_32x32x16_bf16 v[88:103], v[152:155], v[68:71], v[88:103]
  ds_read_b128 v[144:147], v236 offset:62464
  v_rcp_f16_sdwa v132, v132 dst_sel:WORD_1 dst_unused:UNUSED_PRESERVE src0_sel:WORD_1
  v_rcp_f16_sdwa v133, v133 dst_sel:WORD_1 dst_unused:UNUSED_PRESERVE src0_sel:WORD_1
  v_rcp_f16_sdwa v134, v134 dst_sel:WORD_1 dst_unused:UNUSED_PRESERVE src0_sel:WORD_1
  v_rcp_f16_sdwa v135, v135 dst_sel:WORD_1 dst_unused:UNUSED_PRESERVE src0_sel:WORD_1
  s_waitcnt lgkmcnt(3)
  v_mfma_f32_32x32x16_f16 v[32:47], v[156:159], v[116:119], v[32:47]
  ds_read_b128 v[148:151], v237 offset:58368
  v_pk_mul_f16 v104, v120, v128
  v_pk_mul_f16 v105, v121, v129
  v_pk_mul_f16 v106, v122, v130
  v_pk_mul_f16 v107, v123, v131
  v_pk_mul_f16 v108, v124, v132
  v_pk_mul_f16 v109, v125, v133
  v_pk_mul_f16 v110, v126, v134
  v_pk_mul_f16 v111, v127, v135
  s_waitcnt lgkmcnt(3)
  v_mfma_f32_32x32x16_bf16 v[72:87], v[136:139], v[48:51], 0
  ds_read_b128 v[152:155], v236 offset:63488
  v_cvt_pk_f16_f32 v120, v88, v89
  v_cvt_pk_f16_f32 v121, v90, v91
  v_cvt_pk_f16_f32 v122, v92, v93
  v_cvt_pk_f16_f32 v123, v94, v95
  v_cvt_pk_f16_f32 v124, v96, v97
  v_cvt_pk_f16_f32 v125, v98, v99
  v_cvt_pk_f16_f32 v126, v100, v101
  v_cvt_pk_f16_f32 v127, v102, v103
  v_pk_fma_f16 v128, v120, v120, s40
  s_waitcnt lgkmcnt(3)
  v_mfma_f32_32x32x16_f16 v[0:15], v[140:143], v[104:107], v[0:15]
  ds_read_b128 v[156:159], v237 offset:59392
  v_pk_fma_f16 v129, v121, v121, s40
  v_pk_fma_f16 v130, v122, v122, s40
  v_pk_fma_f16 v131, v123, v123, s40
  v_pk_fma_f16 v132, v124, v124, s40
  v_pk_fma_f16 v133, v125, v125, s40
  v_pk_fma_f16 v134, v126, v126, s40
  v_pk_fma_f16 v135, v127, v127, s40
  v_pk_mul_f16 v128, v120, v128
  v_pk_mul_f16 v129, v121, v129
  s_waitcnt lgkmcnt(3)
  v_mfma_f32_32x32x16_bf16 v[72:87], v[144:147], v[52:55], v[72:87]
  ds_read_b128 v[136:139], v236 offset:64512
  v_pk_mul_f16 v130, v122, v130
  v_pk_mul_f16 v131, v123, v131
  v_pk_mul_f16 v132, v124, v132
  v_pk_mul_f16 v133, v125, v133
  v_pk_mul_f16 v134, v126, v134
  v_pk_mul_f16 v135, v127, v135
  v_exp_f16_sdwa v128, -v128 dst_sel:WORD_0 dst_unused:UNUSED_PRESERVE src0_sel:WORD_0
  s_waitcnt lgkmcnt(3)
  v_mfma_f32_32x32x16_f16 v[16:31], v[148:151], v[104:107], v[16:31]
  ds_read_b128 v[140:143], v237 offset:60416
  v_exp_f16_sdwa v129, -v129 dst_sel:WORD_0 dst_unused:UNUSED_PRESERVE src0_sel:WORD_0
  v_exp_f16_sdwa v130, -v130 dst_sel:WORD_0 dst_unused:UNUSED_PRESERVE src0_sel:WORD_0
  v_exp_f16_sdwa v131, -v131 dst_sel:WORD_0 dst_unused:UNUSED_PRESERVE src0_sel:WORD_0
  v_exp_f16_sdwa v132, -v132 dst_sel:WORD_0 dst_unused:UNUSED_PRESERVE src0_sel:WORD_0
  v_exp_f16_sdwa v133, -v133 dst_sel:WORD_0 dst_unused:UNUSED_PRESERVE src0_sel:WORD_0
  s_waitcnt lgkmcnt(3)
  v_mfma_f32_32x32x16_bf16 v[72:87], v[152:155], v[56:59], v[72:87]
  ds_read_b128 v[144:147], v237 offset:0
  v_exp_f16_sdwa v134, -v134 dst_sel:WORD_0 dst_unused:UNUSED_PRESERVE src0_sel:WORD_0
  v_exp_f16_sdwa v135, -v135 dst_sel:WORD_0 dst_unused:UNUSED_PRESERVE src0_sel:WORD_0
  v_exp_f16_sdwa v128, -v128 dst_sel:WORD_1 dst_unused:UNUSED_PRESERVE src0_sel:WORD_1
  v_exp_f16_sdwa v129, -v129 dst_sel:WORD_1 dst_unused:UNUSED_PRESERVE src0_sel:WORD_1
  s_waitcnt lgkmcnt(3)
  v_mfma_f32_32x32x16_f16 v[32:47], v[156:159], v[104:107], v[32:47]
  ds_read_b128 v[148:151], v237 offset:61440
  v_exp_f16_sdwa v130, -v130 dst_sel:WORD_1 dst_unused:UNUSED_PRESERVE src0_sel:WORD_1
  v_exp_f16_sdwa v131, -v131 dst_sel:WORD_1 dst_unused:UNUSED_PRESERVE src0_sel:WORD_1
  v_exp_f16_sdwa v132, -v132 dst_sel:WORD_1 dst_unused:UNUSED_PRESERVE src0_sel:WORD_1
  v_exp_f16_sdwa v133, -v133 dst_sel:WORD_1 dst_unused:UNUSED_PRESERVE src0_sel:WORD_1
  s_waitcnt lgkmcnt(3)
  v_mfma_f32_32x32x16_bf16 v[72:87], v[136:139], v[60:63], v[72:87]
  ds_read_b128 v[152:155], v237 offset:1024
  v_exp_f16_sdwa v134, -v134 dst_sel:WORD_1 dst_unused:UNUSED_PRESERVE src0_sel:WORD_1
  v_exp_f16_sdwa v135, -v135 dst_sel:WORD_1 dst_unused:UNUSED_PRESERVE src0_sel:WORD_1
  v_pk_fma_f16 v128, v128, s41, s41
  v_pk_fma_f16 v129, v129, s41, s41
  v_pk_fma_f16 v130, v130, s41, s41
  v_pk_fma_f16 v131, v131, s41, s41
  v_pk_fma_f16 v132, v132, s41, s41
  s_waitcnt lgkmcnt(3)
  v_mfma_f32_32x32x16_f16 v[0:15], v[140:143], v[108:111], v[0:15]
  ds_read_b128 v[156:159], v237 offset:62464
  v_pk_fma_f16 v133, v133, s41, s41
  v_pk_fma_f16 v134, v134, s41, s41
  v_pk_fma_f16 v135, v135, s41, s41
  v_rcp_f16_sdwa v128, v128 dst_sel:WORD_0 dst_unused:UNUSED_PRESERVE src0_sel:WORD_0
  v_rcp_f16_sdwa v129, v129 dst_sel:WORD_0 dst_unused:UNUSED_PRESERVE src0_sel:WORD_0
  v_rcp_f16_sdwa v130, v130 dst_sel:WORD_0 dst_unused:UNUSED_PRESERVE src0_sel:WORD_0
  s_waitcnt lgkmcnt(3)
  v_mfma_f32_32x32x16_bf16 v[72:87], v[144:147], v[64:67], v[72:87]
  ds_read_b128 v[136:139], v237 offset:2048
  v_rcp_f16_sdwa v131, v131 dst_sel:WORD_0 dst_unused:UNUSED_PRESERVE src0_sel:WORD_0
  v_rcp_f16_sdwa v132, v132 dst_sel:WORD_0 dst_unused:UNUSED_PRESERVE src0_sel:WORD_0
  v_rcp_f16_sdwa v133, v133 dst_sel:WORD_0 dst_unused:UNUSED_PRESERVE src0_sel:WORD_0
  v_rcp_f16_sdwa v134, v134 dst_sel:WORD_0 dst_unused:UNUSED_PRESERVE src0_sel:WORD_0
  s_waitcnt lgkmcnt(3)
  v_mfma_f32_32x32x16_f16 v[16:31], v[148:151], v[108:111], v[16:31]
  ds_read_b128 v[140:143], v237 offset:63488
  v_rcp_f16_sdwa v135, v135 dst_sel:WORD_0 dst_unused:UNUSED_PRESERVE src0_sel:WORD_0
  v_rcp_f16_sdwa v128, v128 dst_sel:WORD_1 dst_unused:UNUSED_PRESERVE src0_sel:WORD_1
  v_rcp_f16_sdwa v129, v129 dst_sel:WORD_1 dst_unused:UNUSED_PRESERVE src0_sel:WORD_1
  v_rcp_f16_sdwa v130, v130 dst_sel:WORD_1 dst_unused:UNUSED_PRESERVE src0_sel:WORD_1
  v_rcp_f16_sdwa v131, v131 dst_sel:WORD_1 dst_unused:UNUSED_PRESERVE src0_sel:WORD_1
  s_waitcnt lgkmcnt(3)
  v_mfma_f32_32x32x16_bf16 v[72:87], v[152:155], v[68:71], v[72:87]
  ds_read_b128 v[144:147], v237 offset:3072
  v_rcp_f16_sdwa v132, v132 dst_sel:WORD_1 dst_unused:UNUSED_PRESERVE src0_sel:WORD_1
  v_rcp_f16_sdwa v133, v133 dst_sel:WORD_1 dst_unused:UNUSED_PRESERVE src0_sel:WORD_1
  v_rcp_f16_sdwa v134, v134 dst_sel:WORD_1 dst_unused:UNUSED_PRESERVE src0_sel:WORD_1
  v_rcp_f16_sdwa v135, v135 dst_sel:WORD_1 dst_unused:UNUSED_PRESERVE src0_sel:WORD_1
  s_waitcnt lgkmcnt(3)
  v_mfma_f32_32x32x16_f16 v[32:47], v[156:159], v[108:111], v[32:47]
  ds_read_b128 v[148:151], v237 offset:64512
  v_pk_mul_f16 v112, v120, v128
  v_pk_mul_f16 v113, v121, v129
  v_pk_mul_f16 v114, v122, v130
  v_pk_mul_f16 v115, v123, v131
  v_pk_mul_f16 v116, v124, v132
  v_pk_mul_f16 v117, v125, v133
  v_pk_mul_f16 v118, v126, v134
  v_pk_mul_f16 v119, v127, v135
  s_waitcnt lgkmcnt(3)
  v_mfma_f32_32x32x16_bf16 v[88:103], v[136:139], v[48:51], 0
  ds_read_b128 v[152:155], v237 offset:4096
  v_cvt_pk_f16_f32 v120, v72, v73
  v_cvt_pk_f16_f32 v121, v74, v75
  v_cvt_pk_f16_f32 v122, v76, v77
  v_cvt_pk_f16_f32 v123, v78, v79
  v_cvt_pk_f16_f32 v124, v80, v81
  v_cvt_pk_f16_f32 v125, v82, v83
  v_cvt_pk_f16_f32 v126, v84, v85
  v_cvt_pk_f16_f32 v127, v86, v87
  v_pk_fma_f16 v128, v120, v120, s40
  s_waitcnt lgkmcnt(3)
  v_mfma_f32_32x32x16_f16 v[0:15], v[140:143], v[112:115], v[0:15]
  ds_read_b128 v[156:159], v238 offset:0
  v_pk_fma_f16 v129, v121, v121, s40
  v_pk_fma_f16 v130, v122, v122, s40
  v_pk_fma_f16 v131, v123, v123, s40
  v_pk_fma_f16 v132, v124, v124, s40
  v_pk_fma_f16 v133, v125, v125, s40
  v_pk_fma_f16 v134, v126, v126, s40
  v_pk_fma_f16 v135, v127, v127, s40
  v_pk_mul_f16 v128, v120, v128
  v_pk_mul_f16 v129, v121, v129
  s_waitcnt lgkmcnt(3)
  v_mfma_f32_32x32x16_bf16 v[88:103], v[144:147], v[52:55], v[88:103]
  ds_read_b128 v[136:139], v237 offset:5120
  v_pk_mul_f16 v130, v122, v130
  v_pk_mul_f16 v131, v123, v131
  v_pk_mul_f16 v132, v124, v132
  v_pk_mul_f16 v133, v125, v133
  v_pk_mul_f16 v134, v126, v134
  v_pk_mul_f16 v135, v127, v135
  v_exp_f16_sdwa v128, -v128 dst_sel:WORD_0 dst_unused:UNUSED_PRESERVE src0_sel:WORD_0
  s_waitcnt lgkmcnt(3)
  v_mfma_f32_32x32x16_f16 v[16:31], v[148:151], v[112:115], v[16:31]
  ds_read_b128 v[140:143], v238 offset:1024
  v_exp_f16_sdwa v129, -v129 dst_sel:WORD_0 dst_unused:UNUSED_PRESERVE src0_sel:WORD_0
  v_exp_f16_sdwa v130, -v130 dst_sel:WORD_0 dst_unused:UNUSED_PRESERVE src0_sel:WORD_0
  v_exp_f16_sdwa v131, -v131 dst_sel:WORD_0 dst_unused:UNUSED_PRESERVE src0_sel:WORD_0
  v_exp_f16_sdwa v132, -v132 dst_sel:WORD_0 dst_unused:UNUSED_PRESERVE src0_sel:WORD_0
  v_exp_f16_sdwa v133, -v133 dst_sel:WORD_0 dst_unused:UNUSED_PRESERVE src0_sel:WORD_0
  s_waitcnt lgkmcnt(3)
  v_mfma_f32_32x32x16_bf16 v[88:103], v[152:155], v[56:59], v[88:103]
  ds_read_b128 v[144:147], v237 offset:6144
  v_exp_f16_sdwa v134, -v134 dst_sel:WORD_0 dst_unused:UNUSED_PRESERVE src0_sel:WORD_0
  v_exp_f16_sdwa v135, -v135 dst_sel:WORD_0 dst_unused:UNUSED_PRESERVE src0_sel:WORD_0
  v_exp_f16_sdwa v128, -v128 dst_sel:WORD_1 dst_unused:UNUSED_PRESERVE src0_sel:WORD_1
  v_exp_f16_sdwa v129, -v129 dst_sel:WORD_1 dst_unused:UNUSED_PRESERVE src0_sel:WORD_1
  s_waitcnt lgkmcnt(3)
  v_mfma_f32_32x32x16_f16 v[32:47], v[156:159], v[112:115], v[32:47]
  ds_read_b128 v[148:151], v238 offset:2048
  v_exp_f16_sdwa v130, -v130 dst_sel:WORD_1 dst_unused:UNUSED_PRESERVE src0_sel:WORD_1
  v_exp_f16_sdwa v131, -v131 dst_sel:WORD_1 dst_unused:UNUSED_PRESERVE src0_sel:WORD_1
  v_exp_f16_sdwa v132, -v132 dst_sel:WORD_1 dst_unused:UNUSED_PRESERVE src0_sel:WORD_1
  v_exp_f16_sdwa v133, -v133 dst_sel:WORD_1 dst_unused:UNUSED_PRESERVE src0_sel:WORD_1
  s_waitcnt lgkmcnt(3)
  v_mfma_f32_32x32x16_bf16 v[88:103], v[136:139], v[60:63], v[88:103]
  ds_read_b128 v[152:155], v237 offset:7168
  v_exp_f16_sdwa v134, -v134 dst_sel:WORD_1 dst_unused:UNUSED_PRESERVE src0_sel:WORD_1
  v_exp_f16_sdwa v135, -v135 dst_sel:WORD_1 dst_unused:UNUSED_PRESERVE src0_sel:WORD_1
  v_pk_fma_f16 v128, v128, s41, s41
  v_pk_fma_f16 v129, v129, s41, s41
  v_pk_fma_f16 v130, v130, s41, s41
  v_pk_fma_f16 v131, v131, s41, s41
  v_pk_fma_f16 v132, v132, s41, s41
  s_waitcnt lgkmcnt(3)
  v_mfma_f32_32x32x16_f16 v[0:15], v[140:143], v[116:119], v[0:15]
  ds_read_b128 v[156:159], v238 offset:3072
  v_pk_fma_f16 v133, v133, s41, s41
  v_pk_fma_f16 v134, v134, s41, s41
  v_pk_fma_f16 v135, v135, s41, s41
  v_rcp_f16_sdwa v128, v128 dst_sel:WORD_0 dst_unused:UNUSED_PRESERVE src0_sel:WORD_0
  v_rcp_f16_sdwa v129, v129 dst_sel:WORD_0 dst_unused:UNUSED_PRESERVE src0_sel:WORD_0
  v_rcp_f16_sdwa v130, v130 dst_sel:WORD_0 dst_unused:UNUSED_PRESERVE src0_sel:WORD_0
  s_waitcnt lgkmcnt(3)
  v_mfma_f32_32x32x16_bf16 v[88:103], v[144:147], v[64:67], v[88:103]
  ds_read_b128 v[136:139], v238 offset:4096
  v_rcp_f16_sdwa v131, v131 dst_sel:WORD_0 dst_unused:UNUSED_PRESERVE src0_sel:WORD_0
  v_rcp_f16_sdwa v132, v132 dst_sel:WORD_0 dst_unused:UNUSED_PRESERVE src0_sel:WORD_0
  v_rcp_f16_sdwa v133, v133 dst_sel:WORD_0 dst_unused:UNUSED_PRESERVE src0_sel:WORD_0
  v_rcp_f16_sdwa v134, v134 dst_sel:WORD_0 dst_unused:UNUSED_PRESERVE src0_sel:WORD_0
  s_waitcnt lgkmcnt(3)
  v_mfma_f32_32x32x16_f16 v[16:31], v[148:151], v[116:119], v[16:31]
  ds_read_b128 v[140:143], v238 offset:5120
  v_rcp_f16_sdwa v135, v135 dst_sel:WORD_0 dst_unused:UNUSED_PRESERVE src0_sel:WORD_0
  v_rcp_f16_sdwa v128, v128 dst_sel:WORD_1 dst_unused:UNUSED_PRESERVE src0_sel:WORD_1
  v_rcp_f16_sdwa v129, v129 dst_sel:WORD_1 dst_unused:UNUSED_PRESERVE src0_sel:WORD_1
  v_rcp_f16_sdwa v130, v130 dst_sel:WORD_1 dst_unused:UNUSED_PRESERVE src0_sel:WORD_1
  v_rcp_f16_sdwa v131, v131 dst_sel:WORD_1 dst_unused:UNUSED_PRESERVE src0_sel:WORD_1
  s_waitcnt lgkmcnt(3)
  v_mfma_f32_32x32x16_bf16 v[88:103], v[152:155], v[68:71], v[88:103]
  ds_read_b128 v[144:147], v238 offset:6144
  v_rcp_f16_sdwa v132, v132 dst_sel:WORD_1 dst_unused:UNUSED_PRESERVE src0_sel:WORD_1
  v_rcp_f16_sdwa v133, v133 dst_sel:WORD_1 dst_unused:UNUSED_PRESERVE src0_sel:WORD_1
  v_rcp_f16_sdwa v134, v134 dst_sel:WORD_1 dst_unused:UNUSED_PRESERVE src0_sel:WORD_1
  v_rcp_f16_sdwa v135, v135 dst_sel:WORD_1 dst_unused:UNUSED_PRESERVE src0_sel:WORD_1
  s_waitcnt lgkmcnt(3)
  v_mfma_f32_32x32x16_f16 v[32:47], v[156:159], v[116:119], v[32:47]
  ds_read_b128 v[148:151], v238 offset:7168
  v_pk_mul_f16 v104, v120, v128
  v_pk_mul_f16 v105, v121, v129
  v_pk_mul_f16 v106, v122, v130
  v_pk_mul_f16 v107, v123, v131
  v_pk_mul_f16 v108, v124, v132
  v_pk_mul_f16 v109, v125, v133
  v_pk_mul_f16 v110, v126, v134
  v_pk_mul_f16 v111, v127, v135
  s_cmp_eq_u32 s39, 3
  s_cbranch_scc1 L_last
  s_waitcnt lgkmcnt(3)
  v_mfma_f32_32x32x16_f16 v[0:15], v[136:139], v[104:107], v[0:15]
  ds_read_b128 v[152:155], v238 offset:8192
  v_cvt_pk_f16_f32 v120, v88, v89
  v_cvt_pk_f16_f32 v121, v90, v91
  v_cvt_pk_f16_f32 v122, v92, v93
  v_cvt_pk_f16_f32 v123, v94, v95
  v_cvt_pk_f16_f32 v124, v96, v97
  v_cvt_pk_f16_f32 v125, v98, v99
  v_cvt_pk_f16_f32 v126, v100, v101
  v_cvt_pk_f16_f32 v127, v102, v103
  s_waitcnt lgkmcnt(3)
  v_mfma_f32_32x32x16_f16 v[16:31], v[140:143], v[104:107], v[16:31]
  ds_read_b128 v[156:159], v238 offset:9216
  v_pk_fma_f16 v128, v120, v120, s40
  v_pk_fma_f16 v129, v121, v121, s40
  v_pk_fma_f16 v130, v122, v122, s40
  v_pk_fma_f16 v131, v123, v123, s40
  v_pk_fma_f16 v132, v124, v124, s40
  v_pk_fma_f16 v133, v125, v125, s40
  v_pk_fma_f16 v134, v126, v126, s40
  v_pk_fma_f16 v135, v127, v127, s40
  s_waitcnt lgkmcnt(3)
  v_mfma_f32_32x32x16_f16 v[32:47], v[144:147], v[104:107], v[32:47]
  ds_read_b128 v[136:139], v240 offset:0
  v_pk_mul_f16 v128, v120, v128
  v_pk_mul_f16 v129, v121, v129
  v_pk_mul_f16 v130, v122, v130
  v_pk_mul_f16 v131, v123, v131
  v_pk_mul_f16 v132, v124, v132
  v_pk_mul_f16 v133, v125, v133
  v_pk_mul_f16 v134, v126, v134
  v_pk_mul_f16 v135, v127, v135
  s_waitcnt lgkmcnt(3)
  v_mfma_f32_32x32x16_f16 v[0:15], v[148:151], v[108:111], v[0:15]
  ds_read_b128 v[140:143], v240 offset:32
  v_exp_f16_sdwa v128, -v128 dst_sel:WORD_0 dst_unused:UNUSED_PRESERVE src0_sel:WORD_0
  v_exp_f16_sdwa v129, -v129 dst_sel:WORD_0 dst_unused:UNUSED_PRESERVE src0_sel:WORD_0
  v_exp_f16_sdwa v130, -v130 dst_sel:WORD_0 dst_unused:UNUSED_PRESERVE src0_sel:WORD_0
  v_exp_f16_sdwa v131, -v131 dst_sel:WORD_0 dst_unused:UNUSED_PRESERVE src0_sel:WORD_0
  s_waitcnt lgkmcnt(3)
  v_mfma_f32_32x32x16_f16 v[16:31], v[152:155], v[108:111], v[16:31]
  ds_read_b128 v[144:147], v240 offset:64
  v_exp_f16_sdwa v132, -v132 dst_sel:WORD_0 dst_unused:UNUSED_PRESERVE src0_sel:WORD_0
  v_exp_f16_sdwa v133, -v133 dst_sel:WORD_0 dst_unused:UNUSED_PRESERVE src0_sel:WORD_0
  v_exp_f16_sdwa v134, -v134 dst_sel:WORD_0 dst_unused:UNUSED_PRESERVE src0_sel:WORD_0
  v_exp_f16_sdwa v135, -v135 dst_sel:WORD_0 dst_unused:UNUSED_PRESERVE src0_sel:WORD_0
  s_waitcnt lgkmcnt(3)
  v_mfma_f32_32x32x16_f16 v[32:47], v[156:159], v[108:111], v[32:47]
  ds_read_b128 v[148:151], v240 offset:96
  v_exp_f16_sdwa v128, -v128 dst_sel:WORD_1 dst_unused:UNUSED_PRESERVE src0_sel:WORD_1
  v_exp_f16_sdwa v129, -v129 dst_sel:WORD_1 dst_unused:UNUSED_PRESERVE src0_sel:WORD_1
  v_exp_f16_sdwa v130, -v130 dst_sel:WORD_1 dst_unused:UNUSED_PRESERVE src0_sel:WORD_1
  v_exp_f16_sdwa v131, -v131 dst_sel:WORD_1 dst_unused:UNUSED_PRESERVE src0_sel:WORD_1
  s_waitcnt vmcnt(0)
  v_mfma_f32_32x32x16_bf16 v[72:87], v[232:235], v[180:183], 0
  v_exp_f16_sdwa v132, -v132 dst_sel:WORD_1 dst_unused:UNUSED_PRESERVE src0_sel:WORD_1
  v_exp_f16_sdwa v133, -v133 dst_sel:WORD_1 dst_unused:UNUSED_PRESERVE src0_sel:WORD_1
  v_exp_f16_sdwa v134, -v134 dst_sel:WORD_1 dst_unused:UNUSED_PRESERVE src0_sel:WORD_1
  v_exp_f16_sdwa v135, -v135 dst_sel:WORD_1 dst_unused:UNUSED_PRESERVE src0_sel:WORD_1
  s_waitcnt lgkmcnt(3)
  v_mfma_f32_32x32x16_bf16 v[184:199], v[136:139], v[160:163], 0
  ds_read_b128 v[152:155], v240 offset:128
  v_pk_fma_f16 v128, v128, s41, s41
  v_pk_fma_f16 v129, v129, s41, s41
  v_pk_fma_f16 v130, v130, s41, s41
  v_pk_fma_f16 v131, v131, s41, s41
  v_pk_fma_f16 v132, v132, s41, s41
  v_pk_fma_f16 v133, v133, s41, s41
  v_pk_fma_f16 v134, v134, s41, s41
  v_pk_fma_f16 v135, v135, s41, s41
  s_waitcnt lgkmcnt(3)
  v_mfma_f32_32x32x16_bf16 v[184:199], v[140:143], v[164:167], v[184:199]
  ds_read_b128 v[156:159], v240 offset:160
  v_rcp_f16_sdwa v128, v128 dst_sel:WORD_0 dst_unused:UNUSED_PRESERVE src0_sel:WORD_0
  v_rcp_f16_sdwa v129, v129 dst_sel:WORD_0 dst_unused:UNUSED_PRESERVE src0_sel:WORD_0
  v_rcp_f16_sdwa v130, v130 dst_sel:WORD_0 dst_unused:UNUSED_PRESERVE src0_sel:WORD_0
  v_rcp_f16_sdwa v131, v131 dst_sel:WORD_0 dst_unused:UNUSED_PRESERVE src0_sel:WORD_0
  s_waitcnt lgkmcnt(3)
  v_mfma_f32_32x32x16_bf16 v[184:199], v[144:147], v[168:171], v[184:199]
  ds_read_b128 v[136:139], v238 offset:10240
  v_rcp_f16_sdwa v132, v132 dst_sel:WORD_0 dst_unused:UNUSED_PRESERVE src0_sel:WORD_0
  v_rcp_f16_sdwa v133, v133 dst_sel:WORD_0 dst_unused:UNUSED_PRESERVE src0_sel:WORD_0
  v_rcp_f16_sdwa v134, v134 dst_sel:WORD_0 dst_unused:UNUSED_PRESERVE src0_sel:WORD_0
  v_rcp_f16_sdwa v135, v135 dst_sel:WORD_0 dst_unused:UNUSED_PRESERVE src0_sel:WORD_0
  s_waitcnt lgkmcnt(3)
  v_mfma_f32_32x32x16_bf16 v[184:199], v[148:151], v[172:175], v[184:199]
  ds_read_b128 v[140:143], v238 offset:11264
  v_rcp_f16_sdwa v128, v128 dst_sel:WORD_1 dst_unused:UNUSED_PRESERVE src0_sel:WORD_1
  v_rcp_f16_sdwa v129, v129 dst_sel:WORD_1 dst_unused:UNUSED_PRESERVE src0_sel:WORD_1
  v_rcp_f16_sdwa v130, v130 dst_sel:WORD_1 dst_unused:UNUSED_PRESERVE src0_sel:WORD_1
  v_rcp_f16_sdwa v131, v131 dst_sel:WORD_1 dst_unused:UNUSED_PRESERVE src0_sel:WORD_1
  s_waitcnt lgkmcnt(3)
  v_mfma_f32_32x32x16_bf16 v[184:199], v[152:155], v[176:179], v[184:199]
  ds_read_b128 v[144:147], v238 offset:12288
  v_rcp_f16_sdwa v132, v132 dst_sel:WORD_1 dst_unused:UNUSED_PRESERVE src0_sel:WORD_1
  v_rcp_f16_sdwa v133, v133 dst_sel:WORD_1 dst_unused:UNUSED_PRESERVE src0_sel:WORD_1
  v_rcp_f16_sdwa v134, v134 dst_sel:WORD_1 dst_unused:UNUSED_PRESERVE src0_sel:WORD_1
  v_rcp_f16_sdwa v135, v135 dst_sel:WORD_1 dst_unused:UNUSED_PRESERVE src0_sel:WORD_1
  s_waitcnt lgkmcnt(3)
  v_mfma_f32_32x32x16_bf16 v[184:199], v[156:159], v[180:183], v[184:199]
  ds_read_b128 v[148:151], v238 offset:13312
  v_pk_mul_f16 v112, v120, v128
  v_pk_mul_f16 v113, v121, v129
  v_pk_mul_f16 v114, v122, v130
  v_pk_mul_f16 v115, v123, v131
  v_pk_mul_f16 v116, v124, v132
  v_pk_mul_f16 v117, v125, v133
  v_pk_mul_f16 v118, v126, v134
  v_pk_mul_f16 v119, v127, v135
  s_waitcnt lgkmcnt(3)
  v_mfma_f32_32x32x16_f16 v[0:15], v[136:139], v[112:115], v[0:15]
  ds_read_b128 v[152:155], v238 offset:14336
  v_mfma_f32_32x32x16_bf16 v[88:103], v[200:203], v[160:163], v[72:87]
  s_waitcnt lgkmcnt(3)
  v_mfma_f32_32x32x16_f16 v[16:31], v[140:143], v[112:115], v[16:31]
  ds_read_b128 v[156:159], v238 offset:15360
  v_mfma_f32_32x32x16_bf16 v[88:103], v[204:207], v[164:167], v[88:103]
  s_waitcnt lgkmcnt(3)
  v_mfma_f32_32x32x16_f16 v[32:47], v[144:147], v[112:115], v[32:47]
  ds_read_b128 v[136:139], v236 offset:0
  v_mfma_f32_32x32x16_bf16 v[120:135], v[208:211], v[168:171], v[72:87]
  s_waitcnt lgkmcnt(3)
  v_mfma_f32_32x32x16_f16 v[0:15], v[148:151], v[116:119], v[0:15]
  ds_read_b128 v[140:143], v236 offset:1024
  v_mfma_f32_32x32x16_bf16 v[120:135], v[212:215], v[172:175], v[120:135]
  v_fmamk_f32 v243, v72, 0x42c00000, v184
  s_waitcnt lgkmcnt(3)
  v_mfma_f32_32x32x16_f16 v[16:31], v[152:155], v[116:119], v[16:31]
  ds_read_b128 v[144:147], v236 offset:2048
  v_mfma_f32_32x32x16_bf16 v[184:199], v[216:219], v[176:179], v[72:87]
  s_waitcnt lgkmcnt(3)
  v_mfma_f32_32x32x16_f16 v[32:47], v[156:159], v[116:119], v[32:47]
  ds_read_b128 v[148:151], v236 offset:3072
  v_mfma_f32_32x32x16_bf16 v[184:199], v[220:223], v[180:183], v[184:199]
  v_pk_mul_f32 v[244:245], v[88:89], v[88:89]
  v_pk_mul_f32 v[246:247], v[90:91], v[90:91]
  v_pk_fma_f32 v[244:245], v[92:93], v[92:93], v[244:245]
  v_pk_fma_f32 v[246:247], v[94:95], v[94:95], v[246:247]
  v_pk_fma_f32 v[244:245], v[96:97], v[96:97], v[244:245]
  v_pk_fma_f32 v[246:247], v[98:99], v[98:99], v[246:247]
  v_pk_fma_f32 v[244:245], v[100:101], v[100:101], v[244:245]
  v_pk_fma_f32 v[246:247], v[102:103], v[102:103], v[246:247]
  v_pk_fma_f32 v[244:245], v[120:121], v[120:121], v[244:245]
  v_pk_fma_f32 v[246:247], v[122:123], v[122:123], v[246:247]
  v_pk_fma_f32 v[244:245], v[124:125], v[124:125], v[244:245]
  v_pk_fma_f32 v[246:247], v[126:127], v[126:127], v[246:247]
  v_pk_fma_f32 v[244:245], v[128:129], v[128:129], v[244:245]
  v_pk_fma_f32 v[246:247], v[130:131], v[130:131], v[246:247]
  v_pk_fma_f32 v[244:245], v[132:133], v[132:133], v[244:245]
  v_pk_fma_f32 v[246:247], v[134:135], v[134:135], v[246:247]
  v_pk_fma_f32 v[244:245], v[184:185], v[184:185], v[244:245]
  v_pk_fma_f32 v[246:247], v[186:187], v[186:187], v[246:247]
  v_pk_fma_f32 v[244:245], v[188:189], v[188:189], v[244:245]
  v_pk_fma_f32 v[246:247], v[190:191], v[190:191], v[246:247]
  v_pk_fma_f32 v[244:245], v[192:193], v[192:193], v[244:245]
  v_pk_fma_f32 v[246:247], v[194:195], v[194:195], v[246:247]
  v_pk_fma_f32 v[244:245], v[196:197], v[196:197], v[244:245]
  v_pk_fma_f32 v[246:247], v[198:199], v[198:199], v[246:247]
  v_add_f32 v244, v244, v245
  v_add_f32 v246, v246, v247
  v_mul_f32 v249, v243, v243
  v_add_f32 v244, v244, v246
  v_mov_b32 v247, 0x383ee32f
  v_mov_b32 v245, v244
  s_nop 1
  v_permlane32_swap_b32 v244, v245
  v_add_f32 v244, v244, v245
  v_fma_f32 v244, v249, s43, v244
  v_fma_f32 v244, |v244|, s42, v247
  v_rsq_f32 v248, v244
  s_nop 0
  v_pk_mul_f32 v[88:89], v[88:89], v[248:249] op_sel_hi:[1,0]
  v_pk_mul_f32 v[90:91], v[90:91], v[248:249] op_sel_hi:[1,0]
  v_pk_mul_f32 v[92:93], v[92:93], v[248:249] op_sel_hi:[1,0]
  v_pk_mul_f32 v[94:95], v[94:95], v[248:249] op_sel_hi:[1,0]
  v_pk_mul_f32 v[96:97], v[96:97], v[248:249] op_sel_hi:[1,0]
  v_pk_mul_f32 v[98:99], v[98:99], v[248:249] op_sel_hi:[1,0]
  v_pk_mul_f32 v[100:101], v[100:101], v[248:249] op_sel_hi:[1,0]
  v_pk_mul_f32 v[102:103], v[102:103], v[248:249] op_sel_hi:[1,0]
  v_cvt_pk_bf16_f32 v48, v88, v89
  v_cvt_pk_bf16_f32 v49, v90, v91
  v_cvt_pk_bf16_f32 v50, v92, v93
  v_cvt_pk_bf16_f32 v51, v94, v95
  v_cvt_pk_bf16_f32 v52, v96, v97
  v_cvt_pk_bf16_f32 v53, v98, v99
  v_cvt_pk_bf16_f32 v54, v100, v101
  v_cvt_pk_bf16_f32 v55, v102, v103
  v_pk_mul_f32 v[120:121], v[120:121], v[248:249] op_sel_hi:[1,0]
  v_pk_mul_f32 v[122:123], v[122:123], v[248:249] op_sel_hi:[1,0]
  v_pk_mul_f32 v[124:125], v[124:125], v[248:249] op_sel_hi:[1,0]
  v_pk_mul_f32 v[126:127], v[126:127], v[248:249] op_sel_hi:[1,0]
  v_pk_mul_f32 v[128:129], v[128:129], v[248:249] op_sel_hi:[1,0]
  v_pk_mul_f32 v[130:131], v[130:131], v[248:249] op_sel_hi:[1,0]
  v_pk_mul_f32 v[132:133], v[132:133], v[248:249] op_sel_hi:[1,0]
  v_pk_mul_f32 v[134:135], v[134:135], v[248:249] op_sel_hi:[1,0]
  v_cvt_pk_bf16_f32 v56, v120, v121
  v_cvt_pk_bf16_f32 v57, v122, v123
  v_cvt_pk_bf16_f32 v58, v124, v125
  v_cvt_pk_bf16_f32 v59, v126, v127
  v_cvt_pk_bf16_f32 v60, v128, v129
  v_cvt_pk_bf16_f32 v61, v130, v131
  v_cvt_pk_bf16_f32 v62, v132, v133
  v_cvt_pk_bf16_f32 v63, v134, v135
  v_pk_mul_f32 v[184:185], v[184:185], v[248:249] op_sel_hi:[1,0]
  v_pk_mul_f32 v[186:187], v[186:187], v[248:249] op_sel_hi:[1,0]
  v_pk_mul_f32 v[188:189], v[188:189], v[248:249] op_sel_hi:[1,0]
  v_pk_mul_f32 v[190:191], v[190:191], v[248:249] op_sel_hi:[1,0]
  v_pk_mul_f32 v[192:193], v[192:193], v[248:249] op_sel_hi:[1,0]
  v_pk_mul_f32 v[194:195], v[194:195], v[248:249] op_sel_hi:[1,0]
  v_pk_mul_f32 v[196:197], v[196:197], v[248:249] op_sel_hi:[1,0]
  v_pk_mul_f32 v[198:199], v[198:199], v[248:249] op_sel_hi:[1,0]
  v_cvt_pk_bf16_f32 v64, v184, v185
  v_cvt_pk_bf16_f32 v65, v186, v187
  v_cvt_pk_bf16_f32 v66, v188, v189
  v_cvt_pk_bf16_f32 v67, v190, v191
  v_cvt_pk_bf16_f32 v68, v192, v193
  v_cvt_pk_bf16_f32 v69, v194, v195
  v_cvt_pk_bf16_f32 v70, v196, v197
  v_cvt_pk_bf16_f32 v71, v198, v199
  v_bfi_b32 v71, v242, s44, v71
  s_waitcnt lgkmcnt(3)
  v_mfma_f32_32x32x16_bf16 v[72:87], v[136:139], v[48:51], 0
  ds_read_b128 v[152:155], v236 offset:4096
  v_add_u32 v250, s37, v251
  v_cvt_pk_bf16_f32 v104, v0, v1
  v_cvt_pk_bf16_f32 v105, v2, v3
  v_cvt_pk_bf16_f32 v106, v4, v5
  v_cvt_pk_bf16_f32 v107, v6, v7
  v_cvt_pk_bf16_f32 v108, v8, v9
  v_cvt_pk_bf16_f32 v109, v10, v11
  s_waitcnt lgkmcnt(3)
  v_mfma_f32_32x32x16_bf16 v[72:87], v[140:143], v[52:55], v[72:87]
  ds_read_b128 v[156:159], v236 offset:5120
  v_cvt_pk_bf16_f32 v110, v12, v13
  v_cvt_pk_bf16_f32 v111, v14, v15
  v_cvt_pk_bf16_f32 v112, v16, v17
  v_cvt_pk_bf16_f32 v113, v18, v19
  v_cvt_pk_bf16_f32 v114, v20, v21
  v_cvt_pk_bf16_f32 v115, v22, v23
  s_waitcnt lgkmcnt(3)
  v_mfma_f32_32x32x16_bf16 v[72:87], v[144:147], v[56:59], v[72:87]
  ds_read_b128 v[136:139], v236 offset:6144
  v_permlane16_swap_b32 v104, v108
  v_permlane16_swap_b32 v105, v109
  v_permlane16_swap_b32 v106, v110
  v_permlane16_swap_b32 v107, v111
  v_cvt_pk_bf16_f32 v116, v24, v25
  v_cvt_pk_bf16_f32 v117, v26, v27
  s_waitcnt lgkmcnt(3)
  v_mfma_f32_32x32x16_bf16 v[72:87], v[148:151], v[60:63], v[72:87]
  ds_read_b128 v[140:143], v236 offset:7168
  v_cvt_pk_bf16_f32 v118, v28, v29
  v_cvt_pk_bf16_f32 v119, v30, v31
  v_cvt_pk_bf16_f32 v120, v32, v33
  v_cvt_pk_bf16_f32 v121, v34, v35
  v_cvt_pk_bf16_f32 v122, v36, v37
  v_cvt_pk_bf16_f32 v123, v38, v39
  s_waitcnt lgkmcnt(3)
  v_mfma_f32_32x32x16_bf16 v[72:87], v[152:155], v[64:67], v[72:87]
  ds_read_b128 v[144:147], v236 offset:8192
  v_permlane16_swap_b32 v112, v116
  v_permlane16_swap_b32 v113, v117
  v_permlane16_swap_b32 v114, v118
  v_permlane16_swap_b32 v115, v119
  v_cvt_pk_bf16_f32 v124, v40, v41
  v_cvt_pk_bf16_f32 v125, v42, v43
  s_waitcnt lgkmcnt(3)
  v_mfma_f32_32x32x16_bf16 v[72:87], v[156:159], v[68:71], v[72:87]
  ds_read_b128 v[148:151], v236 offset:9216
  v_cvt_pk_bf16_f32 v126, v44, v45
  v_cvt_pk_bf16_f32 v127, v46, v47
  v_permlane16_swap_b32 v120, v124
  v_permlane16_swap_b32 v121, v125
  v_permlane16_swap_b32 v122, v126
  v_permlane16_swap_b32 v123, v127
  buffer_store_dwordx4 v[104:107], v250, s[24:27], 0 offen offset:0 sc1
  buffer_store_dwordx4 v[112:115], v250, s[24:27], 0 offen offset:64 sc1
  buffer_store_dwordx4 v[120:123], v250, s[24:27], 0 offen offset:128 sc1
  buffer_store_dwordx4 v[108:111], v250, s[24:27], 0 offen offset:3072 sc1
  buffer_store_dwordx4 v[116:119], v250, s[24:27], 0 offen offset:3136 sc1
  buffer_store_dwordx4 v[124:127], v250, s[24:27], 0 offen offset:3200 sc1
  ds_read_b128 v[0:3], v241 offset:0
  ds_read_b128 v[4:7], v241 offset:16
  ds_read_b128 v[8:11], v241 offset:32
  ds_read_b128 v[12:15], v241 offset:48
  ds_read_b128 v[16:19], v241 offset:128
  ds_read_b128 v[20:23], v241 offset:144
  ds_read_b128 v[24:27], v241 offset:160
  ds_read_b128 v[28:31], v241 offset:176
  ds_read_b128 v[32:35], v241 offset:256
  ds_read_b128 v[36:39], v241 offset:272
  ds_read_b128 v[40:43], v241 offset:288
  s_waitcnt lgkmcnt(13)
  ds_read_b128 v[44:47], v241 offset:304
  s_add_u32 s37, s37, 12582912
  s_add_u32 s38, s38, 12582912
  s_add_u32 s39, s39, 1
  s_branch L_loop
L_last:
  s_waitcnt lgkmcnt(3)
  v_mfma_f32_32x32x16_f16 v[0:15], v[136:139], v[104:107], v[0:15]
  ds_read_b128 v[152:155], v238 offset:8192
  v_cvt_pk_f16_f32 v120, v88, v89
  v_cvt_pk_f16_f32 v121, v90, v91
  v_cvt_pk_f16_f32 v122, v92, v93
  v_cvt_pk_f16_f32 v123, v94, v95
  v_cvt_pk_f16_f32 v124, v96, v97
  v_cvt_pk_f16_f32 v125, v98, v99
  v_cvt_pk_f16_f32 v126, v100, v101
  v_cvt_pk_f16_f32 v127, v102, v103
  v_pk_fma_f16 v128, v120, v120, s40
  v_pk_fma_f16 v129, v121, v121, s40
  v_pk_fma_f16 v130, v122, v122, s40
  v_pk_fma_f16 v131, v123, v123, s40
  v_pk_fma_f16 v132, v124, v124, s40
  v_pk_fma_f16 v133, v125, v125, s40
  v_pk_fma_f16 v134, v126, v126, s40
  v_pk_fma_f16 v135, v127, v127, s40
  v_pk_mul_f16 v128, v120, v128
  v_pk_mul_f16 v129, v121, v129
  s_waitcnt lgkmcnt(3)
  v_mfma_f32_32x32x16_f16 v[16:31], v[140:143], v[104:107], v[16:31]
  ds_read_b128 v[156:159], v238 offset:9216
  v_pk_mul_f16 v130, v122, v130
  v_pk_mul_f16 v131, v123, v131
  v_pk_mul_f16 v132, v124, v132
  v_pk_mul_f16 v133, v125, v133
  v_pk_mul_f16 v134, v126, v134
  v_pk_mul_f16 v135, v127, v135
  v_exp_f16_sdwa v128, -v128 dst_sel:WORD_0 dst_unused:UNUSED_PRESERVE src0_sel:WORD_0
  v_exp_f16_sdwa v129, -v129 dst_sel:WORD_0 dst_unused:UNUSED_PRESERVE src0_sel:WORD_0
  v_exp_f16_sdwa v130, -v130 dst_sel:WORD_0 dst_unused:UNUSED_PRESERVE src0_sel:WORD_0
  v_exp_f16_sdwa v131, -v131 dst_sel:WORD_0 dst_unused:UNUSED_PRESERVE src0_sel:WORD_0
  v_exp_f16_sdwa v132, -v132 dst_sel:WORD_0 dst_unused:UNUSED_PRESERVE src0_sel:WORD_0
  v_exp_f16_sdwa v133, -v133 dst_sel:WORD_0 dst_unused:UNUSED_PRESERVE src0_sel:WORD_0
  s_waitcnt lgkmcnt(3)
  v_mfma_f32_32x32x16_f16 v[32:47], v[144:147], v[104:107], v[32:47]
  ds_read_b128 v[136:139], v238 offset:10240
  v_exp_f16_sdwa v134, -v134 dst_sel:WORD_0 dst_unused:UNUSED_PRESERVE src0_sel:WORD_0
  v_exp_f16_sdwa v135, -v135 dst_sel:WORD_0 dst_unused:UNUSED_PRESERVE src0_sel:WORD_0
  v_exp_f16_sdwa v128, -v128 dst_sel:WORD_1 dst_unused:UNUSED_PRESERVE src0_sel:WORD_1
  v_exp_f16_sdwa v129, -v129 dst_sel:WORD_1 dst_unused:UNUSED_PRESERVE src0_sel:WORD_1
  v_exp_f16_sdwa v130, -v130 dst_sel:WORD_1 dst_unused:UNUSED_PRESERVE src0_sel:WORD_1
  v_exp_f16_sdwa v131, -v131 dst_sel:WORD_1 dst_unused:UNUSED_PRESERVE src0_sel:WORD_1
  v_exp_f16_sdwa v132, -v132 dst_sel:WORD_1 dst_unused:UNUSED_PRESERVE src0_sel:WORD_1
  v_exp_f16_sdwa v133, -v133 dst_sel:WORD_1 dst_unused:UNUSED_PRESERVE src0_sel:WORD_1
  s_waitcnt lgkmcnt(3)
  v_mfma_f32_32x32x16_f16 v[0:15], v[148:151], v[108:111], v[0:15]
  ds_read_b128 v[140:143], v238 offset:11264
  v_exp_f16_sdwa v134, -v134 dst_sel:WORD_1 dst_unused:UNUSED_PRESERVE src0_sel:WORD_1
  v_exp_f16_sdwa v135, -v135 dst_sel:WORD_1 dst_unused:UNUSED_PRESERVE src0_sel:WORD_1
  v_pk_fma_f16 v128, v128, s41, s41
  v_pk_fma_f16 v129, v129, s41, s41
  v_pk_fma_f16 v130, v130, s41, s41
  v_pk_fma_f16 v131, v131, s41, s41
  v_pk_fma_f16 v132, v132, s41, s41
  v_pk_fma_f16 v133, v133, s41, s41
  v_pk_fma_f16 v134, v134, s41, s41
  v_pk_fma_f16 v135, v135, s41, s41
  v_rcp_f16_sdwa v128, v128 dst_sel:WORD_0 dst_unused:UNUSED_PRESERVE src0_sel:WORD_0
  v_rcp_f16_sdwa v129, v129 dst_sel:WORD_0 dst_unused:UNUSED_PRESERVE src0_sel:WORD_0
  v_rcp_f16_sdwa v130, v130 dst_sel:WORD_0 dst_unused:UNUSED_PRESERVE src0_sel:WORD_0
  s_waitcnt lgkmcnt(3)
  v_mfma_f32_32x32x16_f16 v[16:31], v[152:155], v[108:111], v[16:31]
  ds_read_b128 v[144:147], v238 offset:12288
  v_rcp_f16_sdwa v131, v131 dst_sel:WORD_0 dst_unused:UNUSED_PRESERVE src0_sel:WORD_0
  v_rcp_f16_sdwa v132, v132 dst_sel:WORD_0 dst_unused:UNUSED_PRESERVE src0_sel:WORD_0
  v_rcp_f16_sdwa v133, v133 dst_sel:WORD_0 dst_unused:UNUSED_PRESERVE src0_sel:WORD_0
  v_rcp_f16_sdwa v134, v134 dst_sel:WORD_0 dst_unused:UNUSED_PRESERVE src0_sel:WORD_0
  v_rcp_f16_sdwa v135, v135 dst_sel:WORD_0 dst_unused:UNUSED_PRESERVE src0_sel:WORD_0
  v_rcp_f16_sdwa v128, v128 dst_sel:WORD_1 dst_unused:UNUSED_PRESERVE src0_sel:WORD_1
  v_rcp_f16_sdwa v129, v129 dst_sel:WORD_1 dst_unused:UNUSED_PRESERVE src0_sel:WORD_1
  v_rcp_f16_sdwa v130, v130 dst_sel:WORD_1 dst_unused:UNUSED_PRESERVE src0_sel:WORD_1
  v_rcp_f16_sdwa v131, v131 dst_sel:WORD_1 dst_unused:UNUSED_PRESERVE src0_sel:WORD_1
  s_waitcnt lgkmcnt(3)
  v_mfma_f32_32x32x16_f16 v[32:47], v[156:159], v[108:111], v[32:47]
  ds_read_b128 v[148:151], v238 offset:13312
  v_rcp_f16_sdwa v132, v132 dst_sel:WORD_1 dst_unused:UNUSED_PRESERVE src0_sel:WORD_1
  v_rcp_f16_sdwa v133, v133 dst_sel:WORD_1 dst_unused:UNUSED_PRESERVE src0_sel:WORD_1
  v_rcp_f16_sdwa v134, v134 dst_sel:WORD_1 dst_unused:UNUSED_PRESERVE src0_sel:WORD_1
  v_rcp_f16_sdwa v135, v135 dst_sel:WORD_1 dst_unused:UNUSED_PRESERVE src0_sel:WORD_1
  v_pk_mul_f16 v112, v120, v128
  v_pk_mul_f16 v113, v121, v129
  v_pk_mul_f16 v114, v122, v130
  v_pk_mul_f16 v115, v123, v131
  v_pk_mul_f16 v116, v124, v132
  v_pk_mul_f16 v117, v125, v133
  v_pk_mul_f16 v118, v126, v134
  v_pk_mul_f16 v119, v127, v135
  s_waitcnt lgkmcnt(3)
  v_mfma_f32_32x32x16_f16 v[0:15], v[136:139], v[112:115], v[0:15]
  ds_read_b128 v[152:155], v238 offset:14336
  s_waitcnt lgkmcnt(3)
  v_mfma_f32_32x32x16_f16 v[16:31], v[140:143], v[112:115], v[16:31]
  ds_read_b128 v[156:159], v238 offset:15360
  s_waitcnt lgkmcnt(3)
  v_mfma_f32_32x32x16_f16 v[32:47], v[144:147], v[112:115], v[32:47]
  s_waitcnt lgkmcnt(2)
  v_mfma_f32_32x32x16_f16 v[0:15], v[148:151], v[116:119], v[0:15]
  s_waitcnt lgkmcnt(1)
  v_mfma_f32_32x32x16_f16 v[16:31], v[152:155], v[116:119], v[16:31]
  s_waitcnt lgkmcnt(0)
  v_mfma_f32_32x32x16_f16 v[32:47], v[156:159], v[116:119], v[32:47]
  v_add_u32 v250, s37, v251
  s_nop 8
  v_cvt_pk_bf16_f32 v104, v0, v1
  v_cvt_pk_bf16_f32 v105, v2, v3
  v_cvt_pk_bf16_f32 v106, v4, v5
  v_cvt_pk_bf16_f32 v107, v6, v7
  v_cvt_pk_bf16_f32 v108, v8, v9
  v_cvt_pk_bf16_f32 v109, v10, v11
  v_cvt_pk_bf16_f32 v110, v12, v13
  v_cvt_pk_bf16_f32 v111, v14, v15
  v_cvt_pk_bf16_f32 v112, v16, v17
  v_cvt_pk_bf16_f32 v113, v18, v19
  v_cvt_pk_bf16_f32 v114, v20, v21
  v_cvt_pk_bf16_f32 v115, v22, v23
  v_permlane16_swap_b32 v104, v108
  v_permlane16_swap_b32 v105, v109
  v_permlane16_swap_b32 v106, v110
  v_permlane16_swap_b32 v107, v111
  v_cvt_pk_bf16_f32 v116, v24, v25
  v_cvt_pk_bf16_f32 v117, v26, v27
  v_cvt_pk_bf16_f32 v118, v28, v29
  v_cvt_pk_bf16_f32 v119, v30, v31
  v_cvt_pk_bf16_f32 v120, v32, v33
  v_cvt_pk_bf16_f32 v121, v34, v35
  v_cvt_pk_bf16_f32 v122, v36, v37
  v_cvt_pk_bf16_f32 v123, v38, v39
  v_permlane16_swap_b32 v112, v116
  v_permlane16_swap_b32 v113, v117
  v_permlane16_swap_b32 v114, v118
  v_permlane16_swap_b32 v115, v119
  v_cvt_pk_bf16_f32 v124, v40, v41
  v_cvt_pk_bf16_f32 v125, v42, v43
  v_cvt_pk_bf16_f32 v126, v44, v45
  v_cvt_pk_bf16_f32 v127, v46, v47
  v_permlane16_swap_b32 v120, v124
  v_permlane16_swap_b32 v121, v125
  v_permlane16_swap_b32 v122, v126
  v_permlane16_swap_b32 v123, v127
  buffer_store_dwordx4 v[104:107], v250, s[24:27], 0 offen offset:0 sc1
  buffer_store_dwordx4 v[112:115], v250, s[24:27], 0 offen offset:64 sc1
  buffer_store_dwordx4 v[120:123], v250, s[24:27], 0 offen offset:128 sc1
  buffer_store_dwordx4 v[108:111], v250, s[24:27], 0 offen offset:3072 sc1
  buffer_store_dwordx4 v[116:119], v250, s[24:27], 0 offen offset:3136 sc1
  buffer_store_dwordx4 v[124:127], v250, s[24:27], 0 offen offset:3200 sc1
L_end:
  s_endpgm
.section .rodata,"a"
.p2align 6
.amdhsa_kernel standalone__modern_conv_block_convnext__vision_kernel
  .amdhsa_next_free_vgpr 252
  .amdhsa_next_free_sgpr 96
  .amdhsa_accum_offset 252
  .amdhsa_group_segment_fixed_size 0
  .amdhsa_kernarg_size 80
  .amdhsa_user_sgpr_count 2
  .amdhsa_user_sgpr_kernarg_segment_ptr 1
  .amdhsa_system_sgpr_workgroup_id_x 1
.end_amdhsa_kernel
```
